```python
import torch

def _softmax(x, axis=-1):
    return torch.softmax(x, dim=axis)
def _gelu(x):
    return torch.nn.functional.gelu(x, approximate="tanh")
def _silu(x):
    return torch.nn.functional.silu(x)
def _sigmoid(x):
    return torch.sigmoid(x)
def _layernorm(x, axis=-1, eps=1e-5):
    m = x.mean(dim=axis, keepdim=True)
    v = x.var(dim=axis, keepdim=True, unbiased=False)
    return (x - m) / torch.sqrt(v + eps)
def _scatter_add(tgt, idx, src, axis=0):
    return tgt.clone().index_add_(axis, idx, src)
def _segment_sum(src, seg, n):
    out = torch.zeros((n,) + src.shape[1:], dtype=src.dtype)
    return out.index_add_(0, seg, src)
def _pad(x, pw):
    flat = tuple(v for pair in reversed(pw) for v in pair)
    return torch.nn.functional.pad(x, flat)

kernel_name = 'concat_heads__gqa_block_cached__mha_block_cached__decode'

def setup_inputs():

    _w = (lambda a: (lambda t: t.to(torch.bfloat16) if t.is_floating_point() else t)(torch.as_tensor(a)))
    def _A_setup():
        B, Sq, D = 2, 1, 640
        Hq, Hkv, Sk, Dh = 32, 32, 8192, 192
        assert Hq % Hkv == 0, (Hq, Hkv)
        return {
            "x": _w((lambda *s: torch.randn(*s, dtype=torch.bfloat16) * 0.8)(B, Sq, D)),
            "k_cache": _w((lambda *s: torch.randn(*s, dtype=torch.bfloat16) * 0.8)(B, Hkv, Sk, Dh)),
            "v_cache": _w((lambda *s: torch.randn(*s, dtype=torch.bfloat16) * 0.05)(B, Hkv, Sk, Dh)),
            "wq": _w((lambda *s: torch.randn(*s, dtype=torch.bfloat16) * 0.8)(D, Hq * Dh) * (D ** -0.5)),
            "wo": _w((lambda *s: torch.randn(*s, dtype=torch.bfloat16) * 0.05)(Hq * Dh, D) * ((Hq * Dh) ** -0.5)),
        }
    _A_in = _A_setup()

    def _B_setup():
        B, Sq, D = 2, 1, 640
        H, Sk, Dh = 32, 8192, 192
        return {
            "x": _w((lambda *s: torch.randn(*s, dtype=torch.bfloat16) * 0.8)(B, Sq, D)),
            "k_cache": _w((lambda *s: torch.randn(*s, dtype=torch.bfloat16) * 0.8)(B, H, Sk, Dh)),
            "v_cache": _w((lambda *s: torch.randn(*s, dtype=torch.bfloat16) * 0.05)(B, H, Sk, Dh)),
            "wq": _w((lambda *s: torch.randn(*s, dtype=torch.bfloat16) * 0.8)(D, H * Dh) * (D ** -0.5)),
            "wo": _w((lambda *s: torch.randn(*s, dtype=torch.bfloat16) * 0.05)(H * Dh, D) * ((H * Dh) ** -0.5)),
        }
    _B_in = _B_setup()

    return {
        "A_x": _A_in["x"],
        "A_k_cache": _A_in["k_cache"],
        "A_v_cache": _A_in["v_cache"],
        "A_wq": _A_in["wq"],
        "A_wo": _A_in["wo"],
        "B_x": _B_in["x"],
        "B_k_cache": _B_in["k_cache"],
        "B_v_cache": _B_in["v_cache"],
        "B_wq": _B_in["wq"],
        "B_wo": _B_in["wo"],
    }

def reference(A_x, A_k_cache, A_v_cache, A_wq, A_wo, B_x, B_k_cache, B_v_cache, B_wq, B_wo):
    def _A_ref(x, k_cache, v_cache, wq, wo):
        B, Sq, D = x.shape
        Hq, Dh = 32, 192
        Hkv = k_cache.shape[1]
        rep = Hq // Hkv
        q = (lambda x, *d: x.permute(*d))((x @ wq).reshape(B, Sq, Hq, Dh), 0, 2, 1, 3)
        k = (lambda x, n, axis: torch.repeat_interleave(x, n, dim=axis))(k_cache, rep, axis=1)
        v = (lambda x, n, axis: torch.repeat_interleave(x, n, dim=axis))(v_cache, rep, axis=1)
        scores = torch.einsum("bhqd,bhkd->bhqk", q, k) * (Dh ** -0.5)
        p = _softmax(scores, axis=-1)
        o = torch.einsum("bhqk,bhkd->bhqd", p, v)
        return (lambda x, *d: x.permute(*d))(o, 0, 2, 1, 3).reshape(B, Sq, Hq * Dh) @ wo

    def _B_ref(x, k_cache, v_cache, wq, wo):
        B, Sq, D = x.shape
        H, Dh = 32, 192
        q = (lambda x, *d: x.permute(*d))((x @ wq).reshape(B, Sq, H, Dh), 0, 2, 1, 3)
        scores = torch.einsum("bhqd,bhkd->bhqk", q, k_cache) * (Dh ** -0.5)
        p = _softmax(scores, axis=-1)
        o = torch.einsum("bhqk,bhkd->bhqd", p, v_cache)
        return (lambda x, *d: x.permute(*d))(o, 0, 2, 1, 3).reshape(B, Sq, H * Dh) @ wo

    a = _A_ref(A_x, A_k_cache, A_v_cache, A_wq, A_wo)
    b = _B_ref(B_x, B_k_cache, B_v_cache, B_wq, B_wo)
    return torch.concatenate([a, b], axis=-1)
```

```asm
; @launch grid=(256,1,1) block=(256,1,1) lds=65024
.amdgcn_target "amdgcn-amd-amdhsa--gfx950"
.text
.p2align 12
.globl concat_heads__gqa_block_cached__mha_block_cached__decode_kernel
.p2align 8
.type concat_heads__gqa_block_cached__mha_block_cached__decode_kernel,@function
concat_heads__gqa_block_cached__mha_block_cached__decode_kernel:
  s_cmp_ge_u32 s2, 256
  s_cbranch_scc1 L_end
  s_load_dwordx16 s[4:19], s[0:1], 0
  s_load_dwordx8 s[20:27], s[0:1], 64
  s_load_dwordx2 s[28:29], s[0:1], 96
  s_getpc_b64 s[66:67]
L_pc:
  s_add_u32 s66, s66, keytab-L_pc
  s_addc_u32 s67, s67, 0
  s_and_b32 s81, s2, 7
  s_lshr_b32 s30, s2, 3
  s_lshl_b32 s53, s81, 5
  s_add_u32 s53, s53, s30
  s_lshr_b32 s52, s81, 2
  s_lshl_b32 s52, s52, 5
  s_add_u32 s52, s52, s30
  s_mul_i32 s58, s53, 171
  s_lshr_b32 s58, s58, 9
  s_mul_i32 s63, s58, 3
  s_sub_u32 s62, s53, s63
  s_mul_i32 s63, s62, 22
  s_and_b32 s63, s63, 60
  v_lshrrev_b32 v76, 3, v0
  v_lshl_add_u32 v76, v76, 7, s63
  global_load_dwordx4 v[136:139], v76, s[66:67] offset:0
  global_load_dwordx4 v[140:143], v76, s[66:67] offset:16
  global_load_dwordx4 v[144:147], v76, s[66:67] offset:32
  global_load_dwordx4 v[148:151], v76, s[66:67] offset:48
  s_cmp_ge_u32 s30, 2
  s_cbranch_scc1 L_nocpf
  s_sub_u32 s72, s66, keytab-L_pc
  s_subb_u32 s73, s67, 0
  v_lshlrev_b32 v76, 7, v0
  v_min_u32 v76, keytab-L_pc, v76
  global_load_dword v69, v76, s[72:73]
L_nocpf:
  v_lshrrev_b32 v76, 6, v0
  v_and_b32 v0, 63, v0
  v_readfirstlane_b32 s54, v76
  s_and_b32 s56, s81, 3
  v_lshrrev_b32 v76, 3, v0
  v_and_b32 v77, 7, v0
  v_lshlrev_b32 v75, 4, v77
  v_mul_u32_u24 v3, 61440, v76
  v_add_u32 v3, v3, v75
  v_mul_u32_u24 v86, 10, v76
  v_and_b32 v87, 2, v86
  v_and_b32 v86, -4, v86
  s_lshl_b32 s63, s56, 2
  s_add_u32 s63, s63, s54
  s_mul_i32 s64, s63, 491520
  s_mul_i32 s65, s63, 80
  s_mov_b32 s38, 7864320
  s_mov_b32 s39, 0x20000
  s_mov_b32 s42, 2560
  s_mov_b32 s43, 0x20000
  s_mov_b32 s34, 201326592
  s_mov_b32 s35, 0x20000
  s_lshl_b32 s74, s52, 13
  s_lshr_b32 s55, s52, 5
  s_and_b32 s52, s52, 31
  s_mul_i32 s63, s52, 384
  s_add_u32 s64, s64, s63
  s_cmp_eq_u32 s55, 0
  s_waitcnt lgkmcnt(0)
  s_cselect_b64 s[36:37], s[10:11], s[20:21]
  s_cselect_b64 s[40:41], s[4:5], s[14:15]
  buffer_load_dwordx3 v[80:82], v86, s[40:43], s65 offen
  buffer_load_dwordx3 v[200:202], v86, s[40:43], s65 offen offset:1280
  buffer_load_dwordx4 v[124:127], v3, s[36:39], s64 offen offset:0 nt
  buffer_load_dwordx4 v[128:131], v3, s[36:39], s64 offen offset:128 nt
  buffer_load_dwordx4 v[132:135], v3, s[36:39], s64 offen offset:256 nt
  s_add_u32 s64, s64, 12288
  buffer_load_dwordx4 v[152:155], v3, s[36:39], s64 offen offset:0 nt
  buffer_load_dwordx4 v[156:159], v3, s[36:39], s64 offen offset:128 nt
  buffer_load_dwordx4 v[160:163], v3, s[36:39], s64 offen offset:256 nt
  s_add_u32 s64, s64, 12288
  buffer_load_dwordx4 v[164:167], v3, s[36:39], s64 offen offset:0 nt
  buffer_load_dwordx4 v[168:171], v3, s[36:39], s64 offen offset:128 nt
  buffer_load_dwordx4 v[172:175], v3, s[36:39], s64 offen offset:256 nt
  s_add_u32 s64, s64, 12288
  buffer_load_dwordx4 v[176:179], v3, s[36:39], s64 offen offset:0 nt
  buffer_load_dwordx4 v[180:183], v3, s[36:39], s64 offen offset:128 nt
  buffer_load_dwordx4 v[184:187], v3, s[36:39], s64 offen offset:256 nt
  s_add_u32 s64, s64, 12288
  buffer_load_dwordx4 v[188:191], v3, s[36:39], s64 offen offset:0 nt
  buffer_load_dwordx4 v[192:195], v3, s[36:39], s64 offen offset:128 nt
  buffer_load_dwordx4 v[196:199], v3, s[36:39], s64 offen offset:256 nt
  s_load_dword s0, s[28:29], 0
  s_mov_b32 s60, 3407868
  s_load_dword s1, s[28:29], s60
  s_mov_b64 s[32:33], s[6:7]
  s_lshl_b32 s58, s58, 2
  s_add_u32 s58, s58, s62
  s_mul_i32 s58, s58, 196608
  s_mov_b32 s57, s58
  s_cmp_eq_u32 s62, 1
  s_cselect_b32 s26, 6, 5
  s_cmp_eq_u32 s62, 2
  s_cselect_b32 s27, 10, 11
  s_mov_b32 s4, -1
  s_mov_b32 s5, 0x8888
  s_mov_b64 s[44:45], s[28:29]
  s_mov_b32 s46, 3407872
  s_mov_b32 s47, 0x20000
  s_mov_b64 s[48:49], s[24:25]
  s_mov_b32 s50, 5120
  s_mov_b32 s51, 0x20000
  s_mov_b32 s61, 0x3dd53b95
  s_mov_b32 s66, 0x00ff00ff
  s_mov_b32 s67, 0xff00ff00
  s_mov_b32 s72, 0x01010101
  s_mov_b32 s73, 0x01010101
  s_mov_b32 s78, 0x01000100
  s_mov_b32 s79, 0x03020302
  s_mov_b32 s3, 0xffff0000
  s_lshl_b32 s63, s56, 11
  s_add_u32 s74, s74, s63
  s_add_u32 s74, s74, 4096
  s_mul_i32 s31, s53, 512
  s_add_u32 s31, s31, 528384
  v_and_b32 v79, 1, v0
  v_lshlrev_b32 v79, 4, v79
  v_mov_b32 v78, 0xffff
  v_lshlrev_b32 v78, v79, v78
  v_lshrrev_b32 v79, 1, v77
  v_cmp_eq_u32 vcc, 0, v79
  s_nop 1
  v_cndmask_b32 v4, 0, v78, vcc
  v_cmp_eq_u32 vcc, 1, v79
  s_nop 1
  v_cndmask_b32 v5, 0, v78, vcc
  v_cmp_eq_u32 vcc, 2, v79
  s_nop 1
  v_cndmask_b32 v6, 0, v78, vcc
  v_cmp_eq_u32 vcc, 3, v79
  s_nop 1
  v_cndmask_b32 v7, 0, v78, vcc
  v_lshrrev_b32 v79, 5, v0
  v_mul_u32_u24 v70, 768, v79
  v_lshl_add_u32 v70, v77, 5, v70
  v_and_b32 v79, 16, v0
  v_add_u32 v70, v70, v79
  s_mul_i32 s63, s54, 1536
  v_add_u32 v70, s63, v70
  v_add_u32 v218, 27904, v70
  v_mad_u32_u24 v79, v76, 6, v77
  s_mul_i32 s63, s54, 48
  v_add_u32 v79, s63, v79
  v_lshlrev_b32 v71, 2, v79
  v_add_u32 v219, 27904, v71
  s_lshl_b32 s63, s54, 2
  s_add_u32 s63, s63, 15104
  v_mov_b32 v220, s63
  v_mov_b32 v221, 15104
  v_add_u32 v217, 12288, v75
  s_mul_i32 s63, s54, 40
  v_add_lshl_u32 v72, s63, v0, 4
  s_lshl_b32 s63, s54, 3
  v_add_lshl_u32 v73, s63, v76, 4
  s_and_b32 s56, s53, 3
  s_sub_u32 s63, 255, s53
  s_lshr_b32 s55, s63, 7
  s_bfe_u32 s52, s63, 0x50002
  s_cmp_eq_u32 s55, 0
  s_cselect_b64 s[12:13], s[12:13], s[22:23]
  s_mul_i32 s63, s56, 320
  s_lshl_b32 s75, s63, 3
  s_lshl_b32 s64, s55, 5
  s_add_u32 s64, s64, s52
  s_mul_i32 s64, s64, 10240
  s_add_u32 s75, s75, s64
  s_add_u32 s75, s75, 2101248
  s_lshl_b32 s64, s52, 2
  s_add_u32 s64, s64, s54
  s_mul_i32 s64, s64, 61440
  s_add_u32 s77, s63, s64
  v_mov_b32 v64, 0xff7fffff
  s_mov_b32 s59, 0
  v_mov_b32 v1, 15328
  v_mov_b32 v2, 3
  ds_write_b32 v1, v2
  s_waitcnt lgkmcnt(0)
  s_mul_i32 s0, s0, 0x9e3779b1
  s_add_u32 s0, s0, 0x7f4a7c15
  s_mul_i32 s1, s1, 0x2c9277b5
  s_add_u32 s1, s1, 0xac564b05
  s_brev_b32 s60, s1
  s_and_b32 s60, s60, -2
  s_add_u32 s60, s60, s0
  s_waitcnt vmcnt(15)
  v_add_u32 v136, v136, v75
  v_add_u32 v137, v137, v75
  v_add_u32 v138, v138, v75
  v_add_u32 v139, v139, v75
  v_add_u32 v140, v140, v75
  v_add_u32 v141, v141, v75
  v_add_u32 v142, v142, v75
  v_add_u32 v143, v143, v75
  v_add_u32 v144, v144, v75
  v_add_u32 v145, v145, v75
  v_add_u32 v146, v146, v75
  v_add_u32 v147, v147, v75
  v_add_u32 v148, v148, v75
  v_add_u32 v149, v149, v75
  v_add_u32 v150, v150, v75
  v_add_u32 v151, v151, v75
  v_alignbyte_b32 v80, v81, v80, v87
  v_alignbyte_b32 v81, v82, v81, v87
  v_alignbyte_b32 v82, v82, v82, v87
  v_alignbyte_b32 v200, v201, v200, v87
  v_alignbyte_b32 v201, v202, v201, v87
  v_alignbyte_b32 v202, v202, v202, v87
  v_perm_b32 v76, v80, v80, s78
  v_perm_b32 v77, v200, v200, s78
  v_and_b32 v8, v76, v4
  v_and_b32 v9, v76, v5
  v_and_b32 v10, v76, v6
  v_and_b32 v11, v76, v7
  v_and_b32 v12, v77, v4
  v_and_b32 v13, v77, v5
  v_and_b32 v14, v77, v6
  v_and_b32 v15, v77, v7
  s_waitcnt vmcnt(12)
  s_nop 0
  v_mfma_f32_16x16x32_bf16 v[16:19], v[8:11], v[124:127], 0
  v_mfma_f32_16x16x32_bf16 v[20:23], v[8:11], v[128:131], 0
  v_mfma_f32_16x16x32_bf16 v[24:27], v[8:11], v[132:135], 0
  v_mfma_f32_16x16x32_bf16 v[28:31], v[12:15], v[124:127], 0
  v_mfma_f32_16x16x32_bf16 v[32:35], v[12:15], v[128:131], 0
  v_mfma_f32_16x16x32_bf16 v[36:39], v[12:15], v[132:135], 0
  v_perm_b32 v76, v80, v80, s79
  v_perm_b32 v77, v200, v200, s79
  v_and_b32 v8, v76, v4
  v_and_b32 v9, v76, v5
  v_and_b32 v10, v76, v6
  v_and_b32 v11, v76, v7
  v_and_b32 v12, v77, v4
  v_and_b32 v13, v77, v5
  v_and_b32 v14, v77, v6
  v_and_b32 v15, v77, v7
  s_waitcnt vmcnt(9)
  s_nop 0
  v_mfma_f32_16x16x32_bf16 v[16:19], v[8:11], v[152:155], v[16:19]
  v_mfma_f32_16x16x32_bf16 v[20:23], v[8:11], v[156:159], v[20:23]
  v_mfma_f32_16x16x32_bf16 v[24:27], v[8:11], v[160:163], v[24:27]
  v_mfma_f32_16x16x32_bf16 v[28:31], v[12:15], v[152:155], v[28:31]
  v_mfma_f32_16x16x32_bf16 v[32:35], v[12:15], v[156:159], v[32:35]
  v_mfma_f32_16x16x32_bf16 v[36:39], v[12:15], v[160:163], v[36:39]
  v_perm_b32 v76, v81, v81, s78
  v_perm_b32 v77, v201, v201, s78
  v_and_b32 v8, v76, v4
  v_and_b32 v9, v76, v5
  v_and_b32 v10, v76, v6
  v_and_b32 v11, v76, v7
  v_and_b32 v12, v77, v4
  v_and_b32 v13, v77, v5
  v_and_b32 v14, v77, v6
  v_and_b32 v15, v77, v7
  s_waitcnt vmcnt(6)
  s_nop 0
  v_mfma_f32_16x16x32_bf16 v[16:19], v[8:11], v[164:167], v[16:19]
  v_mfma_f32_16x16x32_bf16 v[20:23], v[8:11], v[168:171], v[20:23]
  v_mfma_f32_16x16x32_bf16 v[24:27], v[8:11], v[172:175], v[24:27]
  v_mfma_f32_16x16x32_bf16 v[28:31], v[12:15], v[164:167], v[28:31]
  v_mfma_f32_16x16x32_bf16 v[32:35], v[12:15], v[168:171], v[32:35]
  v_mfma_f32_16x16x32_bf16 v[36:39], v[12:15], v[172:175], v[36:39]
  v_perm_b32 v76, v81, v81, s79
  v_perm_b32 v77, v201, v201, s79
  v_and_b32 v8, v76, v4
  v_and_b32 v9, v76, v5
  v_and_b32 v10, v76, v6
  v_and_b32 v11, v76, v7
  v_and_b32 v12, v77, v4
  v_and_b32 v13, v77, v5
  v_and_b32 v14, v77, v6
  v_and_b32 v15, v77, v7
  s_waitcnt vmcnt(3)
  buffer_load_dwordx4 v[224:227], v136, s[32:35], s57 offen offset:0 nt
  buffer_load_dwordx4 v[228:231], v136, s[32:35], s57 offen offset:128 nt
  buffer_load_dwordx4 v[232:235], v136, s[32:35], s57 offen offset:256 nt
  v_mfma_f32_16x16x32_bf16 v[16:19], v[8:11], v[176:179], v[16:19]
  v_mfma_f32_16x16x32_bf16 v[20:23], v[8:11], v[180:183], v[20:23]
  v_mfma_f32_16x16x32_bf16 v[24:27], v[8:11], v[184:187], v[24:27]
  v_mfma_f32_16x16x32_bf16 v[28:31], v[12:15], v[176:179], v[28:31]
  v_mfma_f32_16x16x32_bf16 v[32:35], v[12:15], v[180:183], v[32:35]
  v_mfma_f32_16x16x32_bf16 v[36:39], v[12:15], v[184:187], v[36:39]
  v_perm_b32 v76, v82, v82, s78
  v_perm_b32 v77, v202, v202, s78
  v_and_b32 v8, v76, v4
  v_and_b32 v9, v76, v5
  v_and_b32 v10, v76, v6
  v_and_b32 v11, v76, v7
  v_and_b32 v12, v77, v4
  v_and_b32 v13, v77, v5
  v_and_b32 v14, v77, v6
  v_and_b32 v15, v77, v7
  s_waitcnt vmcnt(3)
  buffer_load_dwordx4 v[236:239], v137, s[32:35], s57 offen offset:0 nt
  buffer_load_dwordx4 v[240:243], v137, s[32:35], s57 offen offset:128 nt
  buffer_load_dwordx4 v[244:247], v137, s[32:35], s57 offen offset:256 nt
  v_mfma_f32_16x16x32_bf16 v[16:19], v[8:11], v[188:191], v[16:19]
  v_mfma_f32_16x16x32_bf16 v[20:23], v[8:11], v[192:195], v[20:23]
  v_mfma_f32_16x16x32_bf16 v[24:27], v[8:11], v[196:199], v[24:27]
  v_mfma_f32_16x16x32_bf16 v[28:31], v[12:15], v[188:191], v[28:31]
  v_mfma_f32_16x16x32_bf16 v[32:35], v[12:15], v[192:195], v[32:35]
  v_mfma_f32_16x16x32_bf16 v[36:39], v[12:15], v[196:199], v[36:39]
  s_mov_b64 exec, s[66:67]
  s_nop 3
  ds_write_b128 v70, v[16:19] offset:0
  ds_write_b128 v70, v[20:23] offset:256
  ds_write_b128 v70, v[24:27] offset:512
  s_nop 0
  ds_write_b128 v70, v[28:31] offset:6144
  ds_write_b128 v70, v[32:35] offset:6400
  ds_write_b128 v70, v[36:39] offset:6656
  s_mov_b64 exec, -1
  s_waitcnt lgkmcnt(0)
  s_barrier
  ds_read2st64_b32 v[200:201], v71 offset0:0 offset1:3
  ds_read2st64_b32 v[202:203], v71 offset0:6 offset1:9
  ds_read2st64_b32 v[204:205], v71 offset0:12 offset1:15
  ds_read2st64_b32 v[206:207], v71 offset0:18 offset1:21
  ds_read2st64_b32 v[208:209], v71 offset0:24 offset1:27
  ds_read2st64_b32 v[210:211], v71 offset0:30 offset1:33
  ds_read2st64_b32 v[212:213], v71 offset0:36 offset1:39
  ds_read2st64_b32 v[214:215], v71 offset0:42 offset1:45
  v_mov_b32 v83, s60
  v_mov_b32 v87, s60
  v_and_b32 v76, 1, v0
  v_lshlrev_b32 v76, 4, v76
  v_lshl_add_u32 v76, v73, 1, v76
  s_waitcnt lgkmcnt(4)
  v_add_f32 v200, v200, v201
  v_add_f32 v202, v202, v203
  v_add_f32 v204, v204, v205
  v_add_f32 v206, v206, v207
  v_add_f32 v200, v200, v202
  v_add_f32 v204, v204, v206
  v_add_f32 v80, v200, v204
  s_waitcnt lgkmcnt(0)
  v_add_f32 v208, v208, v209
  v_add_f32 v210, v210, v211
  v_add_f32 v212, v212, v213
  v_add_f32 v214, v214, v215
  v_add_f32 v208, v208, v210
  v_add_f32 v212, v212, v214
  v_add_f32 v84, v208, v212
  v_mov_b32_dpp v81, v80 row_shl:1 row_mask:0xf bank_mask:0xf
  v_mov_b32_dpp v82, v80 row_shl:2 row_mask:0xf bank_mask:0xf
  v_mov_b32_dpp v85, v84 row_shl:1 row_mask:0xf bank_mask:0xf
  v_mov_b32_dpp v86, v84 row_shl:2 row_mask:0xf bank_mask:0xf
  s_mov_b32 exec_lo, 0x09090909
  s_mov_b32 exec_hi, 0x09090909
  buffer_store_dwordx4 v[80:83], v76, s[44:47], s74 offen sc1
  buffer_store_dwordx4 v[84:87], v76, s[44:47], s74 offen offset:1024 sc1
  s_cmp_ge_u32 s54, 2
  s_cbranch_scc1 L_noini
  s_lshl_b32 s63, s54, 8
  s_add_u32 s63, s63, s2
  s_lshl_b32 s63, s63, 8
  s_add_u32 s63, s63, 3145728
  s_mov_b64 exec, 1
  buffer_store_dword v83, off, s[44:47], s63 sc1
L_noini:
  s_mov_b64 exec, -1
  v_lshrrev_b32 v78, 4, v0
  v_lshlrev_b32 v3, 11, v78
  v_lshlrev_b32 v78, 3, v78
  v_mov_b32 v79, 0x04020400
  v_bfe_u32 v222, v79, v78, 8
  v_and_b32 v78, 15, v0
  s_lshl_b32 s63, s54, 4
  v_add_u32 v78, s63, v78
  v_lshl_add_u32 v3, v78, 4, v3
  v_mad_u32_u24 v222, v78, 6, v222
  s_add_u32 s63, s53, 0
  s_mul_i32 s63, s63, 43691
  s_lshr_b32 s63, s63, 19
  s_and_b32 s64, s63, 31
  s_lshl_b32 s64, s64, 13
  s_lshr_b32 s63, s63, 5
  s_lshl_b32 s63, s63, 10
  s_add_u32 s63, s63, s64
  s_add_u32 s36, s63, 4096
  s_add_u32 s40, s63, 266240
  s_add_u32 s63, s53, 256
  s_mul_i32 s63, s63, 43691
  s_lshr_b32 s63, s63, 19
  s_and_b32 s64, s63, 31
  s_lshl_b32 s64, s64, 13
  s_lshr_b32 s63, s63, 5
  s_lshl_b32 s63, s63, 10
  s_add_u32 s63, s63, s64
  s_add_u32 s37, s63, 4096
  s_add_u32 s41, s63, 266240
  s_add_u32 s63, s53, 512
  s_mul_i32 s63, s63, 43691
  s_lshr_b32 s63, s63, 19
  s_and_b32 s64, s63, 31
  s_lshl_b32 s64, s64, 13
  s_lshr_b32 s63, s63, 5
  s_lshl_b32 s63, s63, 10
  s_add_u32 s63, s63, s64
  s_add_u32 s38, s63, 4096
  s_add_u32 s42, s63, 266240
  s_waitcnt vmcnt(7)
  buffer_load_dwordx4 v[52:55], v138, s[32:35], s57 offen offset:0 nt
  s_waitcnt vmcnt(7)
  buffer_load_dwordx4 v[56:59], v138, s[32:35], s57 offen offset:128 nt
  s_waitcnt vmcnt(7)
  buffer_load_dwordx4 v[60:63], v138, s[32:35], s57 offen offset:256 nt
  s_waitcnt vmcnt(7)
  buffer_load_dwordx4 v[124:127], v139, s[32:35], s57 offen offset:0 nt
  s_waitcnt vmcnt(7)
  buffer_load_dwordx4 v[128:131], v139, s[32:35], s57 offen offset:128 nt
  s_waitcnt vmcnt(7)
  buffer_load_dwordx4 v[132:135], v139, s[32:35], s57 offen offset:256 nt
  s_waitcnt vmcnt(5)
  buffer_load_dwordx4 v[152:155], v140, s[32:35], s57 offen offset:0 nt
  s_waitcnt vmcnt(5)
  buffer_load_dwordx4 v[156:159], v140, s[32:35], s57 offen offset:128 nt
  s_waitcnt vmcnt(5)
  buffer_load_dwordx4 v[160:163], v140, s[32:35], s57 offen offset:256 nt
  s_waitcnt vmcnt(5)
  buffer_load_dwordx4 v[164:167], v141, s[32:35], s57 offen offset:0 nt
  buffer_load_dwordx4 v[16:19], v3, s[44:47], s36 offen sc1
  s_waitcnt vmcnt(6)
  buffer_load_dwordx4 v[168:171], v141, s[32:35], s57 offen offset:128 nt
  s_waitcnt vmcnt(6)
  buffer_load_dwordx4 v[172:175], v141, s[32:35], s57 offen offset:256 nt
  s_waitcnt vmcnt(6)
  buffer_load_dwordx4 v[176:179], v142, s[32:35], s57 offen offset:0 nt
  s_waitcnt vmcnt(6)
  buffer_load_dwordx4 v[180:183], v142, s[32:35], s57 offen offset:128 nt
  s_waitcnt vmcnt(6)
  buffer_load_dwordx4 v[184:187], v142, s[32:35], s57 offen offset:256 nt
  s_waitcnt vmcnt(6)
  buffer_load_dwordx4 v[188:191], v143, s[32:35], s57 offen offset:0 nt
  s_waitcnt vmcnt(6)
  s_mov_b32 s76, 1000000
L_qchk:
  v_cmp_ne_u32 vcc, s60, v19
  s_cbranch_vccz L_qok
  s_sub_u32 s76, s76, 1
  s_cbranch_scc1 L_qok
  buffer_load_dwordx4 v[16:19], v3, s[44:47], s36 offen sc1
  s_waitcnt vmcnt(0)
  s_branch L_qchk
L_qok:
  v_mov_b32 v19, v18
  v_permlane32_swap_b32 v16, v17
  s_nop 0
  v_permlane32_swap_b32 v18, v19
  v_add_f32 v16, v16, v17
  v_add_f32 v18, v18, v19
  s_nop 1
  v_permlane16_swap_b32 v16, v18
  v_add_f32 v16, v16, v18
  v_cvt_pk_bf16_f32 v16, v16, v16
  ds_write_b16 v222, v16 offset:12288
  buffer_load_dwordx4 v[192:195], v143, s[32:35], s57 offen offset:128 nt
  s_waitcnt lgkmcnt(0)
  s_barrier
  ds_read_b128 v[40:43], v217 offset:0
  ds_read_b128 v[44:47], v217 offset:128
  ds_read_b128 v[48:51], v217 offset:256
  buffer_load_dwordx4 v[196:199], v143, s[32:35], s57 offen offset:256 nt
  buffer_load_dwordx4 v[20:23], v3, s[44:47], s37 offen sc1
  s_waitcnt lgkmcnt(0)
  v_add_u32 v217, 384, v217
  v_dot2_f32_bf16 v200, v224, v40, 0
  v_dot2_f32_bf16 v200, v225, v41, v200
  v_dot2_f32_bf16 v200, v226, v42, v200
  v_dot2_f32_bf16 v200, v227, v43, v200
  v_dot2_f32_bf16 v200, v228, v44, v200
  v_dot2_f32_bf16 v200, v229, v45, v200
  v_dot2_f32_bf16 v200, v230, v46, v200
  v_dot2_f32_bf16 v200, v231, v47, v200
  v_dot2_f32_bf16 v200, v232, v48, v200
  v_dot2_f32_bf16 v200, v233, v49, v200
  v_dot2_f32_bf16 v200, v234, v50, v200
  v_dot2_f32_bf16 v200, v235, v51, v200
  s_nop 2
  v_add_f32_dpp v200, v200, v200 quad_perm:[1,0,3,2] row_mask:0xf bank_mask:0xf
  s_nop 1
  v_add_f32_dpp v200, v200, v200 quad_perm:[2,3,0,1] row_mask:0xf bank_mask:0xf
  s_nop 1
  v_add_f32_dpp v200, v200, v200 row_half_mirror row_mask:0xf bank_mask:0xf
  v_max_f32 v64, v64, v200
  v_dot2_f32_bf16 v201, v236, v40, 0
  v_dot2_f32_bf16 v201, v237, v41, v201
  v_dot2_f32_bf16 v201, v238, v42, v201
  v_dot2_f32_bf16 v201, v239, v43, v201
  v_dot2_f32_bf16 v201, v240, v44, v201
  v_dot2_f32_bf16 v201, v241, v45, v201
  v_dot2_f32_bf16 v201, v242, v46, v201
  v_dot2_f32_bf16 v201, v243, v47, v201
  v_dot2_f32_bf16 v201, v244, v48, v201
  v_dot2_f32_bf16 v201, v245, v49, v201
  v_dot2_f32_bf16 v201, v246, v50, v201
  v_dot2_f32_bf16 v201, v247, v51, v201
  s_nop 2
  v_add_f32_dpp v201, v201, v201 quad_perm:[1,0,3,2] row_mask:0xf bank_mask:0xf
  s_nop 1
  v_add_f32_dpp v201, v201, v201 quad_perm:[2,3,0,1] row_mask:0xf bank_mask:0xf
  s_nop 1
  v_add_f32_dpp v201, v201, v201 row_half_mirror row_mask:0xf bank_mask:0xf
  v_max_f32 v64, v64, v201
  s_waitcnt vmcnt(6)
  buffer_load_dwordx4 v[88:91], v144, s[32:35], s57 offen offset:0 nt
  v_dot2_f32_bf16 v202, v52, v40, 0
  v_dot2_f32_bf16 v202, v53, v41, v202
  v_dot2_f32_bf16 v202, v54, v42, v202
  v_dot2_f32_bf16 v202, v55, v43, v202
  v_dot2_f32_bf16 v202, v56, v44, v202
  v_dot2_f32_bf16 v202, v57, v45, v202
  v_dot2_f32_bf16 v202, v58, v46, v202
  v_dot2_f32_bf16 v202, v59, v47, v202
  v_dot2_f32_bf16 v202, v60, v48, v202
  v_dot2_f32_bf16 v202, v61, v49, v202
  v_dot2_f32_bf16 v202, v62, v50, v202
  v_dot2_f32_bf16 v202, v63, v51, v202
  s_nop 2
  v_add_f32_dpp v202, v202, v202 quad_perm:[1,0,3,2] row_mask:0xf bank_mask:0xf
  s_nop 1
  v_add_f32_dpp v202, v202, v202 quad_perm:[2,3,0,1] row_mask:0xf bank_mask:0xf
  s_nop 1
  v_add_f32_dpp v202, v202, v202 row_half_mirror row_mask:0xf bank_mask:0xf
  v_max_f32 v64, v64, v202
  v_dot2_f32_bf16 v203, v124, v40, 0
  v_dot2_f32_bf16 v203, v125, v41, v203
  v_dot2_f32_bf16 v203, v126, v42, v203
  v_dot2_f32_bf16 v203, v127, v43, v203
  v_dot2_f32_bf16 v203, v128, v44, v203
  v_dot2_f32_bf16 v203, v129, v45, v203
  v_dot2_f32_bf16 v203, v130, v46, v203
  v_dot2_f32_bf16 v203, v131, v47, v203
  v_dot2_f32_bf16 v203, v132, v48, v203
  v_dot2_f32_bf16 v203, v133, v49, v203
  v_dot2_f32_bf16 v203, v134, v50, v203
  v_dot2_f32_bf16 v203, v135, v51, v203
  s_nop 2
  v_add_f32_dpp v203, v203, v203 quad_perm:[1,0,3,2] row_mask:0xf bank_mask:0xf
  s_nop 1
  v_add_f32_dpp v203, v203, v203 quad_perm:[2,3,0,1] row_mask:0xf bank_mask:0xf
  s_nop 1
  v_add_f32_dpp v203, v203, v203 row_half_mirror row_mask:0xf bank_mask:0xf
  v_max_f32 v64, v64, v203
  s_waitcnt vmcnt(6)
  buffer_load_dwordx4 v[92:95], v144, s[32:35], s57 offen offset:128 nt
  v_dot2_f32_bf16 v204, v152, v40, 0
  v_dot2_f32_bf16 v204, v153, v41, v204
  v_dot2_f32_bf16 v204, v154, v42, v204
  v_dot2_f32_bf16 v204, v155, v43, v204
  v_dot2_f32_bf16 v204, v156, v44, v204
  v_dot2_f32_bf16 v204, v157, v45, v204
  v_dot2_f32_bf16 v204, v158, v46, v204
  v_dot2_f32_bf16 v204, v159, v47, v204
  v_dot2_f32_bf16 v204, v160, v48, v204
  v_dot2_f32_bf16 v204, v161, v49, v204
  v_dot2_f32_bf16 v204, v162, v50, v204
  v_dot2_f32_bf16 v204, v163, v51, v204
  s_nop 2
  v_add_f32_dpp v204, v204, v204 quad_perm:[1,0,3,2] row_mask:0xf bank_mask:0xf
  s_nop 1
  v_add_f32_dpp v204, v204, v204 quad_perm:[2,3,0,1] row_mask:0xf bank_mask:0xf
  s_nop 1
  v_add_f32_dpp v204, v204, v204 row_half_mirror row_mask:0xf bank_mask:0xf
  v_max_f32 v64, v64, v204
  v_dot2_f32_bf16 v205, v164, v40, 0
  v_dot2_f32_bf16 v205, v165, v41, v205
  v_dot2_f32_bf16 v205, v166, v42, v205
  v_dot2_f32_bf16 v205, v167, v43, v205
  v_dot2_f32_bf16 v205, v168, v44, v205
  v_dot2_f32_bf16 v205, v169, v45, v205
  v_dot2_f32_bf16 v205, v170, v46, v205
  v_dot2_f32_bf16 v205, v171, v47, v205
  v_dot2_f32_bf16 v205, v172, v48, v205
  v_dot2_f32_bf16 v205, v173, v49, v205
  v_dot2_f32_bf16 v205, v174, v50, v205
  v_dot2_f32_bf16 v205, v175, v51, v205
  s_nop 2
  v_add_f32_dpp v205, v205, v205 quad_perm:[1,0,3,2] row_mask:0xf bank_mask:0xf
  s_nop 1
  v_add_f32_dpp v205, v205, v205 quad_perm:[2,3,0,1] row_mask:0xf bank_mask:0xf
  s_nop 1
  v_add_f32_dpp v205, v205, v205 row_half_mirror row_mask:0xf bank_mask:0xf
  v_max_f32 v64, v64, v205
  s_waitcnt vmcnt(6)
  buffer_load_dwordx4 v[96:99], v144, s[32:35], s57 offen offset:256 nt
  v_dot2_f32_bf16 v206, v176, v40, 0
  v_dot2_f32_bf16 v206, v177, v41, v206
  v_dot2_f32_bf16 v206, v178, v42, v206
  v_dot2_f32_bf16 v206, v179, v43, v206
  v_dot2_f32_bf16 v206, v180, v44, v206
  v_dot2_f32_bf16 v206, v181, v45, v206
  v_dot2_f32_bf16 v206, v182, v46, v206
  v_dot2_f32_bf16 v206, v183, v47, v206
  v_dot2_f32_bf16 v206, v184, v48, v206
  v_dot2_f32_bf16 v206, v185, v49, v206
  v_dot2_f32_bf16 v206, v186, v50, v206
  v_dot2_f32_bf16 v206, v187, v51, v206
  s_nop 2
  v_add_f32_dpp v206, v206, v206 quad_perm:[1,0,3,2] row_mask:0xf bank_mask:0xf
  s_nop 1
  v_add_f32_dpp v206, v206, v206 quad_perm:[2,3,0,1] row_mask:0xf bank_mask:0xf
  s_nop 1
  v_add_f32_dpp v206, v206, v206 row_half_mirror row_mask:0xf bank_mask:0xf
  v_max_f32 v64, v64, v206
  s_waitcnt vmcnt(4)
  v_dot2_f32_bf16 v207, v188, v40, 0
  v_dot2_f32_bf16 v207, v189, v41, v207
  v_dot2_f32_bf16 v207, v190, v42, v207
  v_dot2_f32_bf16 v207, v191, v43, v207
  v_dot2_f32_bf16 v207, v192, v44, v207
  v_dot2_f32_bf16 v207, v193, v45, v207
  v_dot2_f32_bf16 v207, v194, v46, v207
  v_dot2_f32_bf16 v207, v195, v47, v207
  v_dot2_f32_bf16 v207, v196, v48, v207
  v_dot2_f32_bf16 v207, v197, v49, v207
  v_dot2_f32_bf16 v207, v198, v50, v207
  v_dot2_f32_bf16 v207, v199, v51, v207
  s_nop 2
  v_add_f32_dpp v207, v207, v207 quad_perm:[1,0,3,2] row_mask:0xf bank_mask:0xf
  s_nop 1
  v_add_f32_dpp v207, v207, v207 quad_perm:[2,3,0,1] row_mask:0xf bank_mask:0xf
  s_nop 1
  v_add_f32_dpp v207, v207, v207 row_half_mirror row_mask:0xf bank_mask:0xf
  v_max_f32 v64, v64, v207
  buffer_load_dwordx4 v[100:103], v145, s[32:35], s57 offen offset:0 nt
  buffer_load_dwordx4 v[104:107], v145, s[32:35], s57 offen offset:128 nt
  buffer_load_dwordx4 v[108:111], v145, s[32:35], s57 offen offset:256 nt
  s_waitcnt vmcnt(5)
  buffer_load_dwordx4 v[112:115], v146, s[32:35], s57 offen offset:0 nt
  s_mov_b32 s76, 1000000
L_q2chk:
  v_cmp_ne_u32 vcc, s60, v23
  s_cbranch_vccz L_q2ok
  s_sub_u32 s76, s76, 1
  s_cbranch_scc1 L_q2ok
  buffer_load_dwordx4 v[20:23], v3, s[44:47], s37 offen sc1
  s_waitcnt vmcnt(0)
  s_branch L_q2chk
L_q2ok:
  v_mov_b32 v23, v22
  v_permlane32_swap_b32 v20, v21
  s_nop 0
  v_permlane32_swap_b32 v22, v23
  v_add_f32 v20, v20, v21
  v_add_f32 v22, v22, v23
  s_nop 1
  v_permlane16_swap_b32 v20, v22
  v_add_f32 v20, v20, v22
  v_cvt_pk_bf16_f32 v20, v20, v20
  ds_write_b16 v222, v20 offset:12672
  s_waitcnt vmcnt(5)
  buffer_load_dwordx4 v[116:119], v146, s[32:35], s57 offen offset:128 nt
  s_waitcnt lgkmcnt(0)
  v_add_u32 v224, 0, v136
  v_add_u32 v225, 128, v136
  v_add_u32 v226, 256, v136
  v_add_u32 v227, 0, v137
  v_add_u32 v228, 128, v137
  v_add_u32 v229, 256, v137
  v_add_u32 v230, 0, v138
  v_add_u32 v231, 128, v138
  v_add_u32 v232, 256, v138
  v_add_u32 v233, 0, v139
  v_add_u32 v234, 128, v139
  v_add_u32 v235, 256, v139
  v_bfe_u32 v248, v0, 3, 1
  v_lshlrev_b32 v248, v248, v87
  s_mov_b64 vcc, 3
  s_mov_b32 s22, 3
  s_mov_b32 s23, 0
  s_lshl_b32 s63, s55, 6
  s_add_u32 s63, s63, s52
  s_cmp_lt_u32 s63, 74
  s_cselect_b32 s20, 15, 63
  s_branch L_k8
L_k0:
  s_barrier
  s_lshr_b32 s63, s22, 5
  s_cmp_eq_u32 s63, 1
  s_cselect_b32 s22, 3, s22
  s_mov_b32 vcc_lo, s22
  s_and_b64 vcc, vcc, 7
  s_waitcnt vmcnt(7)
  s_cbranch_vccz L_s1
  s_waitcnt vmcnt(5)
  s_bitcmp1_b32 vcc_lo, 1
  s_cbranch_scc0 L_s1
  s_waitcnt vmcnt(4)
  s_bitcmp1_b32 vcc_lo, 2
  s_cbranch_scc0 L_s1
  s_waitcnt vmcnt(3)
L_s1:
  buffer_load_dwordx4 v[120:123], v138, s[32:35], s57 offen offset:256 nt
  v_mov_b32 v152, v168
  v_mov_b32 v168, v184
  v_mov_b32 v184, v200
  v_dot2_f32_bf16 v200, v88, v40, 0
  v_dot2_f32_bf16 v200, v89, v41, v200
  v_dot2_f32_bf16 v200, v90, v42, v200
  v_dot2_f32_bf16 v200, v91, v43, v200
  s_waitcnt vmcnt(7)
  s_cbranch_vccz L_s2
  s_waitcnt vmcnt(5)
  s_bitcmp1_b32 vcc_lo, 1
  s_cbranch_scc0 L_s2
  s_waitcnt vmcnt(4)
L_s2:
  buffer_load_dwordx4 v[124:127], v139, s[32:35], s57 offen offset:0 nt
  v_dot2_f32_bf16 v200, v92, v44, v200
  v_dot2_f32_bf16 v200, v93, v45, v200
  v_dot2_f32_bf16 v200, v94, v46, v200
  v_dot2_f32_bf16 v200, v95, v47, v200
  s_waitcnt vmcnt(7)
  s_cbranch_vccz L_s3
  s_waitcnt vmcnt(5)
  s_bitcmp1_b32 vcc_lo, 1
  s_cbranch_scc0 L_s3
  s_waitcnt vmcnt(4)
L_s3:
  buffer_load_dwordx4 v[128:131], v139, s[32:35], s57 offen offset:128 nt
  v_dot2_f32_bf16 v200, v96, v48, v200
  v_dot2_f32_bf16 v200, v97, v49, v200
  v_dot2_f32_bf16 v200, v98, v50, v200
  v_dot2_f32_bf16 v200, v99, v51, v200
  s_nop 2
  v_add_f32_dpp v200, v200, v200 quad_perm:[1,0,3,2] row_mask:0xf bank_mask:0xf
  s_nop 1
  v_add_f32_dpp v200, v200, v200 quad_perm:[2,3,0,1] row_mask:0xf bank_mask:0xf
  s_nop 1
  v_add_f32_dpp v200, v200, v200 row_half_mirror row_mask:0xf bank_mask:0xf
  v_max_f32 v64, v64, v200
L_k1:
  s_waitcnt vmcnt(7)
  s_cbranch_vccz L_s4
  s_waitcnt vmcnt(5)
  s_bitcmp1_b32 vcc_lo, 1
  s_cbranch_scc0 L_s4
  s_waitcnt vmcnt(4)
L_s4:
  buffer_load_dwordx4 v[132:135], v139, s[32:35], s57 offen offset:256 nt
  v_mov_b32 v153, v169
  v_mov_b32 v169, v185
  v_mov_b32 v185, v201
  v_dot2_f32_bf16 v201, v100, v40, 0
  v_dot2_f32_bf16 v201, v101, v41, v201
  v_dot2_f32_bf16 v201, v102, v42, v201
  v_dot2_f32_bf16 v201, v103, v43, v201
  s_waitcnt vmcnt(7)
  s_cbranch_vccz L_s5
  s_waitcnt vmcnt(5)
  s_bitcmp1_b32 vcc_lo, 1
  s_cbranch_scc0 L_s5
  s_waitcnt vmcnt(4)
L_s5:
  buffer_load_dwordx4 v[88:91], v140, s[32:35], s57 offen offset:0 nt
  v_dot2_f32_bf16 v201, v104, v44, v201
  v_dot2_f32_bf16 v201, v105, v45, v201
  v_dot2_f32_bf16 v201, v106, v46, v201
  v_dot2_f32_bf16 v201, v107, v47, v201
  s_waitcnt vmcnt(7)
  s_cbranch_vccz L_s6
  s_waitcnt vmcnt(5)
  s_bitcmp1_b32 vcc_lo, 1
  s_cbranch_scc0 L_s6
  s_waitcnt vmcnt(4)
L_s6:
  buffer_load_dwordx4 v[92:95], v140, s[32:35], s57 offen offset:128 nt
  v_dot2_f32_bf16 v201, v108, v48, v201
  v_dot2_f32_bf16 v201, v109, v49, v201
  v_dot2_f32_bf16 v201, v110, v50, v201
  v_dot2_f32_bf16 v201, v111, v51, v201
  s_nop 2
  v_add_f32_dpp v201, v201, v201 quad_perm:[1,0,3,2] row_mask:0xf bank_mask:0xf
  s_nop 1
  v_add_f32_dpp v201, v201, v201 quad_perm:[2,3,0,1] row_mask:0xf bank_mask:0xf
  s_nop 1
  v_add_f32_dpp v201, v201, v201 row_half_mirror row_mask:0xf bank_mask:0xf
  v_max_f32 v64, v64, v201
L_k2:
  s_waitcnt vmcnt(7)
  s_cbranch_vccz L_s7
  s_waitcnt vmcnt(5)
  s_bitcmp1_b32 vcc_lo, 1
  s_cbranch_scc0 L_s7
  s_waitcnt vmcnt(4)
  s_bitcmp1_b32 vcc_lo, 2
  s_cbranch_scc0 L_s7
  s_waitcnt vmcnt(3)
L_s7:
  buffer_load_dwordx4 v[96:99], v140, s[32:35], s57 offen offset:256 nt
  v_mov_b32 v154, v170
  v_mov_b32 v170, v186
  v_mov_b32 v186, v202
  v_dot2_f32_bf16 v202, v112, v40, 0
  v_dot2_f32_bf16 v202, v113, v41, v202
  v_dot2_f32_bf16 v202, v114, v42, v202
  v_dot2_f32_bf16 v202, v115, v43, v202
  s_cmp_eq_u32 s4, 5
  s_cselect_b32 s63, 66846720, 0
  s_add_u32 s57, s57, s63
  s_waitcnt vmcnt(7)
  s_cbranch_vccz L_s8
  s_waitcnt vmcnt(5)
  s_bitcmp1_b32 vcc_lo, 1
  s_cbranch_scc0 L_s8
  s_waitcnt vmcnt(4)
L_s8:
  buffer_load_dwordx4 v[100:103], v141, s[32:35], s57 offen offset:0 nt
  v_dot2_f32_bf16 v202, v116, v44, v202
  v_dot2_f32_bf16 v202, v117, v45, v202
  v_dot2_f32_bf16 v202, v118, v46, v202
  v_dot2_f32_bf16 v202, v119, v47, v202
  s_waitcnt vmcnt(7)
  s_cbranch_vccz L_s9
  s_waitcnt vmcnt(5)
  s_bitcmp1_b32 vcc_lo, 1
  s_cbranch_scc0 L_s9
  s_waitcnt vmcnt(4)
L_s9:
  buffer_load_dwordx4 v[104:107], v141, s[32:35], s57 offen offset:128 nt
  v_dot2_f32_bf16 v202, v120, v48, v202
  v_dot2_f32_bf16 v202, v121, v49, v202
  v_dot2_f32_bf16 v202, v122, v50, v202
  v_dot2_f32_bf16 v202, v123, v51, v202
  s_nop 2
  v_add_f32_dpp v202, v202, v202 quad_perm:[1,0,3,2] row_mask:0xf bank_mask:0xf
  s_nop 1
  v_add_f32_dpp v202, v202, v202 quad_perm:[2,3,0,1] row_mask:0xf bank_mask:0xf
  s_nop 1
  v_add_f32_dpp v202, v202, v202 row_half_mirror row_mask:0xf bank_mask:0xf
  v_max_f32 v64, v64, v202
L_k3:
  s_waitcnt vmcnt(7)
  s_cbranch_vccz L_s10
  s_waitcnt vmcnt(5)
  s_bitcmp1_b32 vcc_lo, 1
  s_cbranch_scc0 L_s10
  s_waitcnt vmcnt(4)
L_s10:
  buffer_load_dwordx4 v[108:111], v141, s[32:35], s57 offen offset:256 nt
  v_mov_b32 v155, v171
  v_mov_b32 v171, v187
  v_mov_b32 v187, v203
  v_dot2_f32_bf16 v203, v124, v40, 0
  v_dot2_f32_bf16 v203, v125, v41, v203
  v_dot2_f32_bf16 v203, v126, v42, v203
  v_dot2_f32_bf16 v203, v127, v43, v203
  s_cmp_eq_u32 s4, 6
  s_cselect_b32 s63, 66846720, 0
  s_add_u32 s57, s57, s63
  s_waitcnt vmcnt(7)
  s_cbranch_vccz L_s11
  s_waitcnt vmcnt(5)
  s_bitcmp1_b32 vcc_lo, 1
  s_cbranch_scc0 L_s11
  s_waitcnt vmcnt(4)
L_s11:
  buffer_load_dwordx4 v[112:115], v142, s[32:35], s57 offen offset:0 nt
  v_dot2_f32_bf16 v203, v128, v44, v203
  v_dot2_f32_bf16 v203, v129, v45, v203
  v_dot2_f32_bf16 v203, v130, v46, v203
  v_dot2_f32_bf16 v203, v131, v47, v203
  s_waitcnt vmcnt(7)
  s_cbranch_vccz L_s12
  s_waitcnt vmcnt(5)
  s_bitcmp1_b32 vcc_lo, 1
  s_cbranch_scc0 L_s12
  s_waitcnt vmcnt(4)
L_s12:
  buffer_load_dwordx4 v[116:119], v142, s[32:35], s57 offen offset:128 nt
  v_dot2_f32_bf16 v203, v132, v48, v203
  v_dot2_f32_bf16 v203, v133, v49, v203
  v_dot2_f32_bf16 v203, v134, v50, v203
  v_dot2_f32_bf16 v203, v135, v51, v203
  s_nop 2
  v_add_f32_dpp v203, v203, v203 quad_perm:[1,0,3,2] row_mask:0xf bank_mask:0xf
  s_nop 1
  v_add_f32_dpp v203, v203, v203 quad_perm:[2,3,0,1] row_mask:0xf bank_mask:0xf
  s_nop 1
  v_add_f32_dpp v203, v203, v203 row_half_mirror row_mask:0xf bank_mask:0xf
  v_max_f32 v64, v64, v203
L_k4:
  s_barrier
  s_lshr_b32 s63, s22, 5
  s_cmp_eq_u32 s63, 3
  s_cselect_b32 s22, 3, s22
  s_mov_b32 vcc_lo, s22
  s_and_b64 vcc, vcc, 7
  s_waitcnt vmcnt(7)
  s_cbranch_vccz L_s13
  s_waitcnt vmcnt(5)
  s_bitcmp1_b32 vcc_lo, 1
  s_cbranch_scc0 L_s13
  s_waitcnt vmcnt(4)
  s_bitcmp1_b32 vcc_lo, 2
  s_cbranch_scc0 L_s13
  s_waitcnt vmcnt(3)
L_s13:
  buffer_load_dwordx4 v[120:123], v142, s[32:35], s57 offen offset:256 nt
  v_mov_b32 v156, v172
  v_mov_b32 v172, v188
  v_mov_b32 v188, v204
  v_dot2_f32_bf16 v204, v88, v40, 0
  v_dot2_f32_bf16 v204, v89, v41, v204
  v_dot2_f32_bf16 v204, v90, v42, v204
  v_dot2_f32_bf16 v204, v91, v43, v204
  s_waitcnt vmcnt(7)
  s_cbranch_vccz L_s14
  s_waitcnt vmcnt(5)
  s_bitcmp1_b32 vcc_lo, 1
  s_cbranch_scc0 L_s14
  s_waitcnt vmcnt(4)
L_s14:
  buffer_load_dwordx4 v[124:127], v143, s[32:35], s57 offen offset:0 nt
  v_dot2_f32_bf16 v204, v92, v44, v204
  v_dot2_f32_bf16 v204, v93, v45, v204
  v_dot2_f32_bf16 v204, v94, v46, v204
  v_dot2_f32_bf16 v204, v95, v47, v204
  s_waitcnt vmcnt(7)
  s_cbranch_vccz L_s15
  s_waitcnt vmcnt(5)
  s_bitcmp1_b32 vcc_lo, 1
  s_cbranch_scc0 L_s15
  s_waitcnt vmcnt(4)
L_s15:
  buffer_load_dwordx4 v[128:131], v143, s[32:35], s57 offen offset:128 nt
  v_dot2_f32_bf16 v204, v96, v48, v204
  v_dot2_f32_bf16 v204, v97, v49, v204
  v_dot2_f32_bf16 v204, v98, v50, v204
  v_dot2_f32_bf16 v204, v99, v51, v204
  s_nop 2
  v_add_f32_dpp v204, v204, v204 quad_perm:[1,0,3,2] row_mask:0xf bank_mask:0xf
  s_nop 1
  v_add_f32_dpp v204, v204, v204 quad_perm:[2,3,0,1] row_mask:0xf bank_mask:0xf
  s_nop 1
  v_add_f32_dpp v204, v204, v204 row_half_mirror row_mask:0xf bank_mask:0xf
  v_max_f32 v64, v64, v204
L_k5:
  s_cmp_eq_u32 s4, 5
  s_cbranch_scc0 L_n16
  s_waitcnt vmcnt(7)
  s_cbranch_vccz L_s17
  s_waitcnt vmcnt(6)
  s_bitcmp1_b32 vcc_lo, 1
  s_cbranch_scc0 L_s17
  s_waitcnt vmcnt(5)
L_s17:
  s_branch L_t16
L_n16:
  s_waitcnt vmcnt(7)
  s_cbranch_vccz L_s18
  s_waitcnt vmcnt(5)
  s_bitcmp1_b32 vcc_lo, 1
  s_cbranch_scc0 L_s18
  s_waitcnt vmcnt(4)
L_s18:
L_t16:
  buffer_load_dwordx4 v[132:135], v143, s[32:35], s57 offen offset:256 nt
  s_cmp_lg_u32 s4, 5
  s_cbranch_scc1 L_eK5
  v_max_f32_dpp v64, v64, v64 row_ror:8 row_mask:0xf bank_mask:0xf
  s_nop 1
  v_max_f32_dpp v64, v64, v64 row_bcast:15 row_mask:0xa bank_mask:0xf
  s_nop 1
  v_max_f32_dpp v64, v64, v64 row_bcast:31 row_mask:0xc bank_mask:0xf
  s_nop 1
  v_readlane_b32 s62, v64, 63
  v_mov_b32 v67, v68
  v_mov_b32 v68, v216
  v_mov_b32 v64, 0xff7fffff
  v_mov_b32 v216, s62
  s_waitcnt lgkmcnt(0)
  v_mov_b32 v40, v52
  v_mov_b32 v41, v53
  v_mov_b32 v42, v54
  v_mov_b32 v43, v55
  v_mov_b32 v44, v56
  v_mov_b32 v45, v57
  v_mov_b32 v46, v58
  v_mov_b32 v47, v59
  v_mov_b32 v48, v60
  v_mov_b32 v49, v61
  v_mov_b32 v50, v62
  v_mov_b32 v51, v63
  v_add_u32 v217, 384, v217
L_eK5:
  v_mov_b32 v157, v173
  v_mov_b32 v173, v189
  v_mov_b32 v189, v205
  v_dot2_f32_bf16 v205, v100, v40, 0
  v_dot2_f32_bf16 v205, v101, v41, v205
  v_dot2_f32_bf16 v205, v102, v42, v205
  v_dot2_f32_bf16 v205, v103, v43, v205
  s_waitcnt vmcnt(7)
  s_cbranch_vccz L_s19
  s_waitcnt vmcnt(5)
  s_bitcmp1_b32 vcc_lo, 1
  s_cbranch_scc0 L_s19
  s_waitcnt vmcnt(4)
L_s19:
  buffer_load_dwordx4 v[88:91], v144, s[32:35], s57 offen offset:0 nt
  v_dot2_f32_bf16 v205, v104, v44, v205
  v_dot2_f32_bf16 v205, v105, v45, v205
  v_dot2_f32_bf16 v205, v106, v46, v205
  v_dot2_f32_bf16 v205, v107, v47, v205
  s_waitcnt vmcnt(7)
  s_cbranch_vccz L_s20
  s_waitcnt vmcnt(5)
  s_bitcmp1_b32 vcc_lo, 1
  s_cbranch_scc0 L_s20
  s_waitcnt vmcnt(4)
L_s20:
  buffer_load_dwordx4 v[92:95], v144, s[32:35], s57 offen offset:128 nt
  v_dot2_f32_bf16 v205, v108, v48, v205
  v_dot2_f32_bf16 v205, v109, v49, v205
  v_dot2_f32_bf16 v205, v110, v50, v205
  v_dot2_f32_bf16 v205, v111, v51, v205
  s_nop 2
  v_add_f32_dpp v205, v205, v205 quad_perm:[1,0,3,2] row_mask:0xf bank_mask:0xf
  s_nop 1
  v_add_f32_dpp v205, v205, v205 quad_perm:[2,3,0,1] row_mask:0xf bank_mask:0xf
  s_nop 1
  v_add_f32_dpp v205, v205, v205 row_half_mirror row_mask:0xf bank_mask:0xf
  v_max_f32 v64, v64, v205
L_k6:
  s_cmp_eq_u32 s4, 6
  s_cbranch_scc0 L_n21
  s_waitcnt vmcnt(7)
  s_cbranch_vccz L_s22
  s_waitcnt vmcnt(6)
  s_bitcmp1_b32 vcc_lo, 1
  s_cbranch_scc0 L_s22
  s_waitcnt vmcnt(5)
  s_bitcmp1_b32 vcc_lo, 2
  s_cbranch_scc0 L_s22
  s_waitcnt vmcnt(4)
L_s22:
  s_branch L_t21
L_n21:
  s_waitcnt vmcnt(7)
  s_cbranch_vccz L_s23
  s_waitcnt vmcnt(5)
  s_bitcmp1_b32 vcc_lo, 1
  s_cbranch_scc0 L_s23
  s_waitcnt vmcnt(4)
  s_bitcmp1_b32 vcc_lo, 2
  s_cbranch_scc0 L_s23
  s_waitcnt vmcnt(3)
L_s23:
L_t21:
  buffer_load_dwordx4 v[96:99], v144, s[32:35], s57 offen offset:256 nt
  s_cmp_lg_u32 s4, 6
  s_cbranch_scc1 L_eK6
  v_max_f32_dpp v64, v64, v64 row_ror:8 row_mask:0xf bank_mask:0xf
  s_nop 1
  v_max_f32_dpp v64, v64, v64 row_bcast:15 row_mask:0xa bank_mask:0xf
  s_nop 1
  v_max_f32_dpp v64, v64, v64 row_bcast:31 row_mask:0xc bank_mask:0xf
  s_nop 1
  v_readlane_b32 s62, v64, 63
  v_mov_b32 v67, v68
  v_mov_b32 v68, v216
  v_mov_b32 v64, 0xff7fffff
  v_mov_b32 v216, s62
  s_waitcnt lgkmcnt(0)
  v_mov_b32 v40, v52
  v_mov_b32 v41, v53
  v_mov_b32 v42, v54
  v_mov_b32 v43, v55
  v_mov_b32 v44, v56
  v_mov_b32 v45, v57
  v_mov_b32 v46, v58
  v_mov_b32 v47, v59
  v_mov_b32 v48, v60
  v_mov_b32 v49, v61
  v_mov_b32 v50, v62
  v_mov_b32 v51, v63
  v_add_u32 v217, 384, v217
L_eK6:
  v_mov_b32 v158, v174
  v_mov_b32 v174, v190
  v_mov_b32 v190, v206
  v_dot2_f32_bf16 v206, v112, v40, 0
  v_dot2_f32_bf16 v206, v113, v41, v206
  v_dot2_f32_bf16 v206, v114, v42, v206
  v_dot2_f32_bf16 v206, v115, v43, v206
  s_waitcnt vmcnt(7)
  s_cbranch_vccz L_s24
  s_waitcnt vmcnt(5)
  s_bitcmp1_b32 vcc_lo, 1
  s_cbranch_scc0 L_s24
  s_waitcnt vmcnt(4)
L_s24:
  buffer_load_dwordx4 v[100:103], v145, s[32:35], s57 offen offset:0 nt
  v_dot2_f32_bf16 v206, v116, v44, v206
  v_dot2_f32_bf16 v206, v117, v45, v206
  v_dot2_f32_bf16 v206, v118, v46, v206
  v_dot2_f32_bf16 v206, v119, v47, v206
  s_waitcnt vmcnt(7)
  s_cbranch_vccz L_s25
  s_waitcnt vmcnt(5)
  s_bitcmp1_b32 vcc_lo, 1
  s_cbranch_scc0 L_s25
  s_waitcnt vmcnt(4)
L_s25:
  buffer_load_dwordx4 v[104:107], v145, s[32:35], s57 offen offset:128 nt
  v_dot2_f32_bf16 v206, v120, v48, v206
  v_dot2_f32_bf16 v206, v121, v49, v206
  v_dot2_f32_bf16 v206, v122, v50, v206
  v_dot2_f32_bf16 v206, v123, v51, v206
  s_nop 2
  v_add_f32_dpp v206, v206, v206 quad_perm:[1,0,3,2] row_mask:0xf bank_mask:0xf
  s_nop 1
  v_add_f32_dpp v206, v206, v206 quad_perm:[2,3,0,1] row_mask:0xf bank_mask:0xf
  s_nop 1
  v_add_f32_dpp v206, v206, v206 row_half_mirror row_mask:0xf bank_mask:0xf
  v_max_f32 v64, v64, v206
L_k7:
  s_waitcnt vmcnt(7)
  s_cbranch_vccz L_s26
  s_waitcnt vmcnt(5)
  s_bitcmp1_b32 vcc_lo, 1
  s_cbranch_scc0 L_s26
  s_waitcnt vmcnt(4)
L_s26:
  buffer_load_dwordx4 v[108:111], v145, s[32:35], s57 offen offset:256 nt
  v_mov_b32 v159, v175
  v_mov_b32 v175, v191
  v_mov_b32 v191, v207
  v_dot2_f32_bf16 v207, v124, v40, 0
  v_dot2_f32_bf16 v207, v125, v41, v207
  v_dot2_f32_bf16 v207, v126, v42, v207
  v_dot2_f32_bf16 v207, v127, v43, v207
  s_cmp_eq_u32 s4, 10
  s_cselect_b32 s63, 66846720, 0
  s_add_u32 s57, s57, s63
  s_waitcnt vmcnt(7)
  s_cbranch_vccz L_s27
  s_waitcnt vmcnt(5)
  s_bitcmp1_b32 vcc_lo, 1
  s_cbranch_scc0 L_s27
  s_waitcnt vmcnt(4)
L_s27:
  buffer_load_dwordx4 v[112:115], v146, s[32:35], s57 offen offset:0 nt
  v_dot2_f32_bf16 v207, v128, v44, v207
  v_dot2_f32_bf16 v207, v129, v45, v207
  v_dot2_f32_bf16 v207, v130, v46, v207
  v_dot2_f32_bf16 v207, v131, v47, v207
  s_waitcnt vmcnt(7)
  s_cbranch_vccz L_s28
  s_waitcnt vmcnt(5)
  s_bitcmp1_b32 vcc_lo, 1
  s_cbranch_scc0 L_s28
  s_waitcnt vmcnt(4)
L_s28:
  buffer_load_dwordx4 v[116:119], v146, s[32:35], s57 offen offset:128 nt
  v_dot2_f32_bf16 v207, v132, v48, v207
  v_dot2_f32_bf16 v207, v133, v49, v207
  v_dot2_f32_bf16 v207, v134, v50, v207
  v_dot2_f32_bf16 v207, v135, v51, v207
  s_nop 2
  v_add_f32_dpp v207, v207, v207 quad_perm:[1,0,3,2] row_mask:0xf bank_mask:0xf
  s_nop 1
  v_add_f32_dpp v207, v207, v207 quad_perm:[2,3,0,1] row_mask:0xf bank_mask:0xf
  s_nop 1
  v_add_f32_dpp v207, v207, v207 row_half_mirror row_mask:0xf bank_mask:0xf
  v_max_f32 v64, v64, v207
L_k8:
  s_barrier
  ds_read_b128 v[52:55], v217 offset:0
  ds_read_b128 v[56:59], v217 offset:128
  ds_read_b128 v[60:63], v217 offset:256
  s_cmp_lg_u32 s54, 0
  s_cbranch_scc1 L_cK
  s_add_u32 s80, s60, 8
  s_mov_b32 s63, 65534
  s_bitcmp1_b32 s63, s59
  s_cbranch_scc0 L_cK
  s_lshl1_add_u32 s63, s59, 1
  s_mul_i32 s63, s63, s81
  s_add_u32 s63, s63, s30
  s_and_b32 s63, s63, 31
  s_lshl_b32 s63, s63, 3
  s_and_b32 s64, s59, 7
  s_add_u32 s63, s63, s64
  s_lshr_b32 s64, s59, 3
  s_lshl_b32 s64, s64, 8
  s_add_u32 s63, s63, s64
  s_lshl_b32 s63, s63, 8
  s_add_u32 s63, s63, 3145728
  s_mov_b32 s80, 1
  s_atomic_add s80, s[28:29], s63 glc
L_cK:
  s_waitcnt vmcnt(7)
  s_cbranch_vccz L_s29
  s_waitcnt vmcnt(5)
  s_bitcmp1_b32 vcc_lo, 1
  s_cbranch_scc0 L_s29
  s_waitcnt vmcnt(4)
  s_bitcmp1_b32 vcc_lo, 2
  s_cbranch_scc0 L_s29
  s_waitcnt vmcnt(3)
L_s29:
  buffer_load_dwordx4 v[120:123], v146, s[32:35], s57 offen offset:256 nt
  v_mov_b32 v160, v176
  v_mov_b32 v176, v192
  v_mov_b32 v192, v208
  v_dot2_f32_bf16 v208, v88, v40, 0
  v_dot2_f32_bf16 v208, v89, v41, v208
  v_dot2_f32_bf16 v208, v90, v42, v208
  v_dot2_f32_bf16 v208, v91, v43, v208
  s_cmp_eq_u32 s4, 11
  s_cselect_b32 s63, 66846720, 0
  s_add_u32 s57, s57, s63
  s_waitcnt vmcnt(7)
  s_cbranch_vccz L_s30
  s_waitcnt vmcnt(5)
  s_bitcmp1_b32 vcc_lo, 1
  s_cbranch_scc0 L_s30
  s_waitcnt vmcnt(4)
L_s30:
  buffer_load_dwordx4 v[124:127], v147, s[32:35], s57 offen offset:0 nt
  v_dot2_f32_bf16 v208, v92, v44, v208
  v_dot2_f32_bf16 v208, v93, v45, v208
  v_dot2_f32_bf16 v208, v94, v46, v208
  v_dot2_f32_bf16 v208, v95, v47, v208
  s_waitcnt vmcnt(7)
  s_cbranch_vccz L_s31
  s_waitcnt vmcnt(5)
  s_bitcmp1_b32 vcc_lo, 1
  s_cbranch_scc0 L_s31
  s_waitcnt vmcnt(4)
L_s31:
  buffer_load_dwordx4 v[128:131], v147, s[32:35], s57 offen offset:128 nt
  v_dot2_f32_bf16 v208, v96, v48, v208
  v_dot2_f32_bf16 v208, v97, v49, v208
  v_dot2_f32_bf16 v208, v98, v50, v208
  v_dot2_f32_bf16 v208, v99, v51, v208
  s_nop 2
  v_add_f32_dpp v208, v208, v208 quad_perm:[1,0,3,2] row_mask:0xf bank_mask:0xf
  s_nop 1
  v_add_f32_dpp v208, v208, v208 quad_perm:[2,3,0,1] row_mask:0xf bank_mask:0xf
  s_nop 1
  v_add_f32_dpp v208, v208, v208 row_half_mirror row_mask:0xf bank_mask:0xf
  v_max_f32 v64, v64, v208
L_k9:
  s_waitcnt vmcnt(7)
  s_cbranch_vccz L_s32
  s_waitcnt vmcnt(5)
  s_bitcmp1_b32 vcc_lo, 1
  s_cbranch_scc0 L_s32
  s_waitcnt vmcnt(4)
L_s32:
  buffer_load_dwordx4 v[132:135], v147, s[32:35], s57 offen offset:256 nt
  v_mov_b32 v161, v177
  v_mov_b32 v177, v193
  v_mov_b32 v193, v209
  v_dot2_f32_bf16 v209, v100, v40, 0
  v_dot2_f32_bf16 v209, v101, v41, v209
  v_dot2_f32_bf16 v209, v102, v42, v209
  v_dot2_f32_bf16 v209, v103, v43, v209
  s_waitcnt vmcnt(7)
  s_cbranch_vccz L_s33
  s_waitcnt vmcnt(5)
  s_bitcmp1_b32 vcc_lo, 1
  s_cbranch_scc0 L_s33
  s_waitcnt vmcnt(4)
L_s33:
  buffer_load_dwordx4 v[88:91], v148, s[32:35], s57 offen offset:0 nt
  v_dot2_f32_bf16 v209, v104, v44, v209
  v_dot2_f32_bf16 v209, v105, v45, v209
  v_dot2_f32_bf16 v209, v106, v46, v209
  v_dot2_f32_bf16 v209, v107, v47, v209
  s_waitcnt vmcnt(7)
  s_cbranch_vccz L_s34
  s_waitcnt vmcnt(5)
  s_bitcmp1_b32 vcc_lo, 1
  s_cbranch_scc0 L_s34
  s_waitcnt vmcnt(4)
L_s34:
  buffer_load_dwordx4 v[92:95], v148, s[32:35], s57 offen offset:128 nt
  v_dot2_f32_bf16 v209, v108, v48, v209
  v_dot2_f32_bf16 v209, v109, v49, v209
  v_dot2_f32_bf16 v209, v110, v50, v209
  v_dot2_f32_bf16 v209, v111, v51, v209
  s_nop 2
  v_add_f32_dpp v209, v209, v209 quad_perm:[1,0,3,2] row_mask:0xf bank_mask:0xf
  s_nop 1
  v_add_f32_dpp v209, v209, v209 quad_perm:[2,3,0,1] row_mask:0xf bank_mask:0xf
  s_nop 1
  v_add_f32_dpp v209, v209, v209 row_half_mirror row_mask:0xf bank_mask:0xf
  v_max_f32 v64, v64, v209
L_k10:
  s_cmp_lg_u32 s54, 0
  s_cbranch_scc1 L_dK
  s_waitcnt lgkmcnt(0)
  s_sub_u32 s80, s80, s60
  s_mov_b32 s14, 50529031
  s_mov_b32 s15, 16867617
  s_lshl_b32 s64, s80, 3
  s_lshr_b64 s[14:15], s[14:15], s64
  s_and_b32 s14, s14, 0xff
  s_cmp_lt_u32 s80, 8
  s_cselect_b32 s63, s14, 3
  s_add_u32 s23, s23, 1
  s_sub_u32 s64, s80, 7
  s_cmp_lt_u32 s64, 1
  s_cselect_b32 s23, s23, 0
  s_cmp_ge_u32 s23, 2
  s_cselect_b32 s63, 0, s63
  v_mov_b32 v2, s63
  ds_write_b32 v1, v2
L_dK:
  s_cmp_eq_u32 s4, 10
  s_cbranch_scc0 L_n35
  s_waitcnt vmcnt(7)
  s_cbranch_vccz L_s36
  s_waitcnt vmcnt(6)
  s_bitcmp1_b32 vcc_lo, 1
  s_cbranch_scc0 L_s36
  s_waitcnt vmcnt(5)
  s_bitcmp1_b32 vcc_lo, 2
  s_cbranch_scc0 L_s36
  s_waitcnt vmcnt(4)
L_s36:
  s_branch L_t35
L_n35:
  s_waitcnt vmcnt(7)
  s_cbranch_vccz L_s37
  s_waitcnt vmcnt(5)
  s_bitcmp1_b32 vcc_lo, 1
  s_cbranch_scc0 L_s37
  s_waitcnt vmcnt(4)
  s_bitcmp1_b32 vcc_lo, 2
  s_cbranch_scc0 L_s37
  s_waitcnt vmcnt(3)
L_s37:
L_t35:
  buffer_load_dwordx4 v[96:99], v148, s[32:35], s57 offen offset:256 nt
  s_cmp_lg_u32 s4, 10
  s_cbranch_scc1 L_eK10
  v_max_f32_dpp v64, v64, v64 row_ror:8 row_mask:0xf bank_mask:0xf
  s_nop 1
  v_max_f32_dpp v64, v64, v64 row_bcast:15 row_mask:0xa bank_mask:0xf
  s_nop 1
  v_max_f32_dpp v64, v64, v64 row_bcast:31 row_mask:0xc bank_mask:0xf
  s_nop 1
  v_readlane_b32 s62, v64, 63
  v_mov_b32 v67, v68
  v_mov_b32 v68, v216
  v_mov_b32 v64, 0xff7fffff
  v_mov_b32 v216, s62
  s_waitcnt lgkmcnt(0)
  v_mov_b32 v40, v52
  v_mov_b32 v41, v53
  v_mov_b32 v42, v54
  v_mov_b32 v43, v55
  v_mov_b32 v44, v56
  v_mov_b32 v45, v57
  v_mov_b32 v46, v58
  v_mov_b32 v47, v59
  v_mov_b32 v48, v60
  v_mov_b32 v49, v61
  v_mov_b32 v50, v62
  v_mov_b32 v51, v63
  v_add_u32 v217, 384, v217
L_eK10:
  v_mov_b32 v162, v178
  v_mov_b32 v178, v194
  v_mov_b32 v194, v210
  v_dot2_f32_bf16 v210, v112, v40, 0
  v_dot2_f32_bf16 v210, v113, v41, v210
  v_dot2_f32_bf16 v210, v114, v42, v210
  v_dot2_f32_bf16 v210, v115, v43, v210
  ds_read_b32 v2, v1
  s_waitcnt vmcnt(7)
  s_cbranch_vccz L_s38
  s_waitcnt vmcnt(5)
  s_bitcmp1_b32 vcc_lo, 1
  s_cbranch_scc0 L_s38
  s_waitcnt vmcnt(4)
L_s38:
  buffer_load_dwordx4 v[100:103], v149, s[32:35], s57 offen offset:0 nt
  v_dot2_f32_bf16 v210, v116, v44, v210
  v_dot2_f32_bf16 v210, v117, v45, v210
  v_dot2_f32_bf16 v210, v118, v46, v210
  v_dot2_f32_bf16 v210, v119, v47, v210
  s_waitcnt lgkmcnt(0)
  v_readfirstlane_b32 s22, v2
  s_nop 3
  s_mov_b32 vcc_lo, s22
  s_and_b64 vcc, vcc, 7
  s_waitcnt vmcnt(7)
  s_cbranch_vccz L_s39
  s_waitcnt vmcnt(5)
  s_bitcmp1_b32 vcc_lo, 1
  s_cbranch_scc0 L_s39
  s_waitcnt vmcnt(4)
L_s39:
  buffer_load_dwordx4 v[104:107], v149, s[32:35], s57 offen offset:128 nt
  v_dot2_f32_bf16 v210, v120, v48, v210
  v_dot2_f32_bf16 v210, v121, v49, v210
  v_dot2_f32_bf16 v210, v122, v50, v210
  v_dot2_f32_bf16 v210, v123, v51, v210
  s_nop 2
  v_add_f32_dpp v210, v210, v210 quad_perm:[1,0,3,2] row_mask:0xf bank_mask:0xf
  s_nop 1
  v_add_f32_dpp v210, v210, v210 quad_perm:[2,3,0,1] row_mask:0xf bank_mask:0xf
  s_nop 1
  v_add_f32_dpp v210, v210, v210 row_half_mirror row_mask:0xf bank_mask:0xf
  v_max_f32 v64, v64, v210
L_k11:
  s_cmp_eq_u32 s4, 11
  s_cbranch_scc0 L_n40
  s_waitcnt vmcnt(7)
  s_cbranch_vccz L_s41
  s_waitcnt vmcnt(6)
  s_bitcmp1_b32 vcc_lo, 1
  s_cbranch_scc0 L_s41
  s_waitcnt vmcnt(5)
L_s41:
  s_branch L_t40
L_n40:
  s_waitcnt vmcnt(7)
  s_cbranch_vccz L_s42
  s_waitcnt vmcnt(5)
  s_bitcmp1_b32 vcc_lo, 1
  s_cbranch_scc0 L_s42
  s_waitcnt vmcnt(4)
L_s42:
L_t40:
  buffer_load_dwordx4 v[108:111], v149, s[32:35], s57 offen offset:256 nt
  s_cmp_lg_u32 s4, 11
  s_cbranch_scc1 L_eK11
  v_max_f32_dpp v64, v64, v64 row_ror:8 row_mask:0xf bank_mask:0xf
  s_nop 1
  v_max_f32_dpp v64, v64, v64 row_bcast:15 row_mask:0xa bank_mask:0xf
  s_nop 1
  v_max_f32_dpp v64, v64, v64 row_bcast:31 row_mask:0xc bank_mask:0xf
  s_nop 1
  v_readlane_b32 s62, v64, 63
  v_mov_b32 v67, v68
  v_mov_b32 v68, v216
  v_mov_b32 v64, 0xff7fffff
  v_mov_b32 v216, s62
  s_waitcnt lgkmcnt(0)
  v_mov_b32 v40, v52
  v_mov_b32 v41, v53
  v_mov_b32 v42, v54
  v_mov_b32 v43, v55
  v_mov_b32 v44, v56
  v_mov_b32 v45, v57
  v_mov_b32 v46, v58
  v_mov_b32 v47, v59
  v_mov_b32 v48, v60
  v_mov_b32 v49, v61
  v_mov_b32 v50, v62
  v_mov_b32 v51, v63
  v_add_u32 v217, 384, v217
L_eK11:
  v_mov_b32 v163, v179
  v_mov_b32 v179, v195
  v_mov_b32 v195, v211
  v_dot2_f32_bf16 v211, v124, v40, 0
  v_dot2_f32_bf16 v211, v125, v41, v211
  v_dot2_f32_bf16 v211, v126, v42, v211
  v_dot2_f32_bf16 v211, v127, v43, v211
  s_cmp_ge_u32 s59, 4
  s_cbranch_scc1 L_nq0
  buffer_load_dwordx4 v[24:27], v3, s[44:47], s38 offen sc1
L_nq0:
  s_cmp_lt_u32 s59, 4
  s_cbranch_scc0 L_n43
  s_waitcnt vmcnt(7)
  s_cbranch_vccz L_s44
  s_waitcnt vmcnt(6)
  s_bitcmp1_b32 vcc_lo, 1
  s_cbranch_scc0 L_s44
  s_waitcnt vmcnt(5)
L_s44:
  s_branch L_t43
L_n43:
  s_waitcnt vmcnt(7)
  s_cbranch_vccz L_s45
  s_waitcnt vmcnt(5)
  s_bitcmp1_b32 vcc_lo, 1
  s_cbranch_scc0 L_s45
  s_waitcnt vmcnt(4)
L_s45:
L_t43:
  buffer_load_dwordx4 v[112:115], v150, s[32:35], s57 offen offset:0 nt
  v_dot2_f32_bf16 v211, v128, v44, v211
  v_dot2_f32_bf16 v211, v129, v45, v211
  v_dot2_f32_bf16 v211, v130, v46, v211
  v_dot2_f32_bf16 v211, v131, v47, v211
  ds_read_b32 v2, v1
  s_cmp_lt_u32 s59, 4
  s_cbranch_scc0 L_n46
  s_waitcnt vmcnt(7)
  s_cbranch_vccz L_s47
  s_waitcnt vmcnt(6)
  s_bitcmp1_b32 vcc_lo, 1
  s_cbranch_scc0 L_s47
  s_waitcnt vmcnt(5)
L_s47:
  s_branch L_t46
L_n46:
  s_waitcnt vmcnt(7)
  s_cbranch_vccz L_s48
  s_waitcnt vmcnt(5)
  s_bitcmp1_b32 vcc_lo, 1
  s_cbranch_scc0 L_s48
  s_waitcnt vmcnt(4)
L_s48:
L_t46:
  buffer_load_dwordx4 v[116:119], v150, s[32:35], s57 offen offset:128 nt
  v_dot2_f32_bf16 v211, v132, v48, v211
  v_dot2_f32_bf16 v211, v133, v49, v211
  v_dot2_f32_bf16 v211, v134, v50, v211
  v_dot2_f32_bf16 v211, v135, v51, v211
  s_nop 2
  v_add_f32_dpp v211, v211, v211 quad_perm:[1,0,3,2] row_mask:0xf bank_mask:0xf
  s_nop 1
  v_add_f32_dpp v211, v211, v211 quad_perm:[2,3,0,1] row_mask:0xf bank_mask:0xf
  s_nop 1
  v_add_f32_dpp v211, v211, v211 row_half_mirror row_mask:0xf bank_mask:0xf
  v_max_f32 v64, v64, v211
L_k12:
  s_barrier
  s_waitcnt lgkmcnt(0)
  v_readfirstlane_b32 s22, v2
  s_nop 3
  s_mov_b32 vcc_lo, s22
  s_and_b64 vcc, vcc, 7
  s_cmp_lt_u32 s59, 4
  s_cbranch_scc0 L_n49
  s_waitcnt vmcnt(7)
  s_cbranch_vccz L_s50
  s_waitcnt vmcnt(6)
  s_bitcmp1_b32 vcc_lo, 1
  s_cbranch_scc0 L_s50
  s_waitcnt vmcnt(5)
  s_bitcmp1_b32 vcc_lo, 2
  s_cbranch_scc0 L_s50
  s_waitcnt vmcnt(4)
L_s50:
  s_branch L_t49
L_n49:
  s_waitcnt vmcnt(7)
  s_cbranch_vccz L_s51
  s_waitcnt vmcnt(5)
  s_bitcmp1_b32 vcc_lo, 1
  s_cbranch_scc0 L_s51
  s_waitcnt vmcnt(4)
  s_bitcmp1_b32 vcc_lo, 2
  s_cbranch_scc0 L_s51
  s_waitcnt vmcnt(3)
L_s51:
L_t49:
  buffer_load_dwordx4 v[120:123], v150, s[32:35], s57 offen offset:256 nt
  v_mov_b32 v164, v180
  v_mov_b32 v180, v196
  v_mov_b32 v196, v212
  v_dot2_f32_bf16 v212, v88, v40, 0
  v_dot2_f32_bf16 v212, v89, v41, v212
  v_dot2_f32_bf16 v212, v90, v42, v212
  v_dot2_f32_bf16 v212, v91, v43, v212
  s_cmp_lt_u32 s59, 4
  s_cbranch_scc0 L_n52
  s_waitcnt vmcnt(7)
  s_cbranch_vccz L_s53
  s_waitcnt vmcnt(6)
  s_bitcmp1_b32 vcc_lo, 1
  s_cbranch_scc0 L_s53
  s_waitcnt vmcnt(5)
L_s53:
  s_branch L_t52
L_n52:
  s_waitcnt vmcnt(7)
  s_cbranch_vccz L_s54
  s_waitcnt vmcnt(5)
  s_bitcmp1_b32 vcc_lo, 1
  s_cbranch_scc0 L_s54
  s_waitcnt vmcnt(4)
L_s54:
L_t52:
  buffer_load_dwordx4 v[124:127], v151, s[32:35], s57 offen offset:0 nt
  v_dot2_f32_bf16 v212, v92, v44, v212
  v_dot2_f32_bf16 v212, v93, v45, v212
  v_dot2_f32_bf16 v212, v94, v46, v212
  v_dot2_f32_bf16 v212, v95, v47, v212
  s_cmp_lt_u32 s59, 4
  s_cbranch_scc0 L_n55
  s_waitcnt vmcnt(7)
  s_cbranch_vccz L_s56
  s_waitcnt vmcnt(6)
  s_bitcmp1_b32 vcc_lo, 1
  s_cbranch_scc0 L_s56
  s_waitcnt vmcnt(5)
L_s56:
  s_branch L_t55
L_n55:
  s_waitcnt vmcnt(7)
  s_cbranch_vccz L_s57
  s_waitcnt vmcnt(5)
  s_bitcmp1_b32 vcc_lo, 1
  s_cbranch_scc0 L_s57
  s_waitcnt vmcnt(4)
L_s57:
L_t55:
  buffer_load_dwordx4 v[128:131], v151, s[32:35], s57 offen offset:128 nt
  v_dot2_f32_bf16 v212, v96, v48, v212
  v_dot2_f32_bf16 v212, v97, v49, v212
  v_dot2_f32_bf16 v212, v98, v50, v212
  v_dot2_f32_bf16 v212, v99, v51, v212
  s_nop 2
  v_add_f32_dpp v212, v212, v212 quad_perm:[1,0,3,2] row_mask:0xf bank_mask:0xf
  s_nop 1
  v_add_f32_dpp v212, v212, v212 quad_perm:[2,3,0,1] row_mask:0xf bank_mask:0xf
  s_nop 1
  v_add_f32_dpp v212, v212, v212 row_half_mirror row_mask:0xf bank_mask:0xf
  v_max_f32 v64, v64, v212
L_k13:
  s_cmp_lt_u32 s59, 4
  s_cbranch_scc0 L_n58
  s_waitcnt vmcnt(7)
  s_cbranch_vccz L_s59
  s_waitcnt vmcnt(6)
  s_bitcmp1_b32 vcc_lo, 1
  s_cbranch_scc0 L_s59
  s_waitcnt vmcnt(5)
L_s59:
  s_branch L_t58
L_n58:
  s_waitcnt vmcnt(7)
  s_cbranch_vccz L_s60
  s_waitcnt vmcnt(5)
  s_bitcmp1_b32 vcc_lo, 1
  s_cbranch_scc0 L_s60
  s_waitcnt vmcnt(4)
L_s60:
L_t58:
  buffer_load_dwordx4 v[132:135], v151, s[32:35], s57 offen offset:256 nt
  v_mov_b32 v165, v181
  v_mov_b32 v181, v197
  v_mov_b32 v197, v213
  v_dot2_f32_bf16 v213, v100, v40, 0
  v_dot2_f32_bf16 v213, v101, v41, v213
  v_dot2_f32_bf16 v213, v102, v42, v213
  v_dot2_f32_bf16 v213, v103, v43, v213
  s_add_u32 s63, s59, 1
  s_add_u32 s57, s57, 196608
  s_and_b32 s64, s63, 3
  s_cselect_b32 s57, s57, s58
  s_cmp_eq_u32 s63, 4
  s_cselect_b64 s[32:33], s[8:9], s[32:33]
  s_cmp_eq_u32 s63, 12
  s_cselect_b64 s[32:33], s[18:19], s[32:33]
  s_waitcnt vmcnt(7)
  s_cbranch_vccz L_s61
  s_waitcnt vmcnt(5)
  s_bitcmp1_b32 vcc_lo, 1
  s_cbranch_scc0 L_s61
  s_waitcnt vmcnt(4)
L_s61:
  buffer_load_dwordx4 v[88:91], v136, s[32:35], s57 offen offset:0 nt
  v_dot2_f32_bf16 v213, v104, v44, v213
  v_dot2_f32_bf16 v213, v105, v45, v213
  v_dot2_f32_bf16 v213, v106, v46, v213
  v_dot2_f32_bf16 v213, v107, v47, v213
  ds_read_b32 v2, v1
  s_cmp_ge_u32 s59, 4
  s_cbranch_scc1 L_nq1
  s_waitcnt vmcnt(7)
  s_mov_b32 s76, 1000000
L_q3chk:
  v_cmp_ne_u32 vcc, s60, v27
  s_cbranch_vccz L_q3ok
  s_sub_u32 s76, s76, 1
  s_cbranch_scc1 L_q3ok
  buffer_load_dwordx4 v[24:27], v3, s[44:47], s38 offen sc1
  s_waitcnt vmcnt(0)
  s_branch L_q3chk
L_q3ok:
  v_mov_b32 v27, v26
  v_permlane32_swap_b32 v24, v25
  s_nop 0
  v_permlane32_swap_b32 v26, v27
  v_add_f32 v24, v24, v25
  v_add_f32 v26, v26, v27
  s_nop 1
  v_permlane16_swap_b32 v24, v26
  v_add_f32 v24, v24, v26
  v_cvt_pk_bf16_f32 v24, v24, v24
  ds_write_b16 v222, v24 offset:13056
  s_mov_b32 s38, s40
  s_mov_b32 s40, s41
  s_mov_b32 s41, s42
  s_waitcnt lgkmcnt(0)
  v_add_u32 v222, 384, v222
  s_mov_b32 vcc_lo, s22
  s_and_b64 vcc, vcc, 7
L_nq1:
  s_waitcnt vmcnt(7)
  s_cbranch_vccz L_s62
  s_waitcnt vmcnt(5)
  s_bitcmp1_b32 vcc_lo, 1
  s_cbranch_scc0 L_s62
  s_waitcnt vmcnt(4)
L_s62:
  buffer_load_dwordx4 v[92:95], v136, s[32:35], s57 offen offset:128 nt
  v_dot2_f32_bf16 v213, v108, v48, v213
  v_dot2_f32_bf16 v213, v109, v49, v213
  v_dot2_f32_bf16 v213, v110, v50, v213
  v_dot2_f32_bf16 v213, v111, v51, v213
  s_nop 2
  v_add_f32_dpp v213, v213, v213 quad_perm:[1,0,3,2] row_mask:0xf bank_mask:0xf
  s_nop 1
  v_add_f32_dpp v213, v213, v213 quad_perm:[2,3,0,1] row_mask:0xf bank_mask:0xf
  s_nop 1
  v_add_f32_dpp v213, v213, v213 row_half_mirror row_mask:0xf bank_mask:0xf
  v_max_f32 v64, v64, v213
L_k14:
  s_waitcnt lgkmcnt(0)
  v_readfirstlane_b32 s22, v2
  s_nop 3
  s_mov_b32 vcc_lo, s22
  s_and_b64 vcc, vcc, 7
  s_waitcnt vmcnt(7)
  s_cbranch_vccz L_s63
  s_waitcnt vmcnt(5)
  s_bitcmp1_b32 vcc_lo, 1
  s_cbranch_scc0 L_s63
  s_waitcnt vmcnt(4)
  s_bitcmp1_b32 vcc_lo, 2
  s_cbranch_scc0 L_s63
  s_waitcnt vmcnt(3)
L_s63:
  buffer_load_dwordx4 v[96:99], v136, s[32:35], s57 offen offset:256 nt
  v_mov_b32 v166, v182
  v_mov_b32 v182, v198
  v_mov_b32 v198, v214
  v_dot2_f32_bf16 v214, v112, v40, 0
  v_dot2_f32_bf16 v214, v113, v41, v214
  v_dot2_f32_bf16 v214, v114, v42, v214
  v_dot2_f32_bf16 v214, v115, v43, v214
  s_waitcnt vmcnt(7)
  s_cbranch_vccz L_s64
  s_waitcnt vmcnt(5)
  s_bitcmp1_b32 vcc_lo, 1
  s_cbranch_scc0 L_s64
  s_waitcnt vmcnt(4)
L_s64:
  buffer_load_dwordx4 v[100:103], v137, s[32:35], s57 offen offset:0 nt
  v_dot2_f32_bf16 v214, v116, v44, v214
  v_dot2_f32_bf16 v214, v117, v45, v214
  v_dot2_f32_bf16 v214, v118, v46, v214
  v_dot2_f32_bf16 v214, v119, v47, v214
  s_waitcnt vmcnt(7)
  s_cbranch_vccz L_s65
  s_waitcnt vmcnt(5)
  s_bitcmp1_b32 vcc_lo, 1
  s_cbranch_scc0 L_s65
  s_waitcnt vmcnt(4)
L_s65:
  buffer_load_dwordx4 v[104:107], v137, s[32:35], s57 offen offset:128 nt
  v_dot2_f32_bf16 v214, v120, v48, v214
  v_dot2_f32_bf16 v214, v121, v49, v214
  v_dot2_f32_bf16 v214, v122, v50, v214
  v_dot2_f32_bf16 v214, v123, v51, v214
  s_nop 2
  v_add_f32_dpp v214, v214, v214 quad_perm:[1,0,3,2] row_mask:0xf bank_mask:0xf
  s_nop 1
  v_add_f32_dpp v214, v214, v214 quad_perm:[2,3,0,1] row_mask:0xf bank_mask:0xf
  s_nop 1
  v_add_f32_dpp v214, v214, v214 row_half_mirror row_mask:0xf bank_mask:0xf
  v_max_f32 v64, v64, v214
L_k15:
  s_waitcnt vmcnt(7)
  s_cbranch_vccz L_s66
  s_waitcnt vmcnt(5)
  s_bitcmp1_b32 vcc_lo, 1
  s_cbranch_scc0 L_s66
  s_waitcnt vmcnt(4)
L_s66:
  buffer_load_dwordx4 v[108:111], v137, s[32:35], s57 offen offset:256 nt
  v_mov_b32 v167, v183
  v_mov_b32 v183, v199
  v_mov_b32 v199, v215
  v_dot2_f32_bf16 v215, v124, v40, 0
  v_dot2_f32_bf16 v215, v125, v41, v215
  v_dot2_f32_bf16 v215, v126, v42, v215
  v_dot2_f32_bf16 v215, v127, v43, v215
  s_waitcnt vmcnt(7)
  s_cbranch_vccz L_s67
  s_waitcnt vmcnt(5)
  s_bitcmp1_b32 vcc_lo, 1
  s_cbranch_scc0 L_s67
  s_waitcnt vmcnt(4)
L_s67:
  buffer_load_dwordx4 v[112:115], v138, s[32:35], s57 offen offset:0 nt
  v_dot2_f32_bf16 v215, v128, v44, v215
  v_dot2_f32_bf16 v215, v129, v45, v215
  v_dot2_f32_bf16 v215, v130, v46, v215
  v_dot2_f32_bf16 v215, v131, v47, v215
  s_waitcnt vmcnt(7)
  s_cbranch_vccz L_s68
  s_waitcnt vmcnt(5)
  s_bitcmp1_b32 vcc_lo, 1
  s_cbranch_scc0 L_s68
  s_waitcnt vmcnt(4)
L_s68:
  buffer_load_dwordx4 v[116:119], v138, s[32:35], s57 offen offset:128 nt
  v_dot2_f32_bf16 v215, v132, v48, v215
  v_dot2_f32_bf16 v215, v133, v49, v215
  v_dot2_f32_bf16 v215, v134, v50, v215
  v_dot2_f32_bf16 v215, v135, v51, v215
  s_nop 2
  v_add_f32_dpp v215, v215, v215 quad_perm:[1,0,3,2] row_mask:0xf bank_mask:0xf
  s_nop 1
  v_add_f32_dpp v215, v215, v215 quad_perm:[2,3,0,1] row_mask:0xf bank_mask:0xf
  s_nop 1
  v_add_f32_dpp v215, v215, v215 row_half_mirror row_mask:0xf bank_mask:0xf
  v_max_f32 v64, v64, v215
  s_add_u32 s59, s59, 1
  s_and_b32 s63, s59, 3
  s_cmp_eq_u32 s63, 1
  s_cselect_b32 s4, s26, -1
  s_cmp_eq_u32 s63, 2
  s_cselect_b32 s4, s27, s4
  s_cmp_lg_u32 s63, 0
  s_cbranch_scc1 L_k0
  v_max_f32_dpp v64, v64, v64 row_ror:8 row_mask:0xf bank_mask:0xf
  s_nop 1
  v_max_f32_dpp v64, v64, v64 row_bcast:15 row_mask:0xa bank_mask:0xf
  s_nop 1
  v_max_f32_dpp v64, v64, v64 row_bcast:31 row_mask:0xc bank_mask:0xf
  s_nop 1
  v_readlane_b32 s62, v64, 63
  v_mov_b32 v67, v68
  v_mov_b32 v68, v216
  v_mov_b32 v64, 0xff7fffff
  v_mov_b32 v216, s62
  v_mov_b32 v16, 0
  v_mov_b32 v17, 0
  v_mov_b32 v18, 0
  v_mov_b32 v19, 0
  v_mov_b32 v20, 0
  v_mov_b32 v21, 0
  v_mov_b32 v22, 0
  v_mov_b32 v23, 0
  v_mov_b32 v24, 0
  v_mov_b32 v25, 0
  v_mov_b32 v26, 0
  v_mov_b32 v27, 0
  v_mov_b32 v65, 0
  v_mul_f32 v66, s61, v67
L_v0:
  s_barrier
  s_lshr_b32 s63, s22, 5
  s_cmp_eq_u32 s63, 1
  s_cselect_b32 s22, 3, s22
  s_mov_b32 vcc_lo, s22
  s_and_b64 vcc, vcc, 7
  s_waitcnt vmcnt(7)
  s_cbranch_vccz L_s69
  s_waitcnt vmcnt(5)
  s_bitcmp1_b32 vcc_lo, 1
  s_cbranch_scc0 L_s69
  s_waitcnt vmcnt(4)
  s_bitcmp1_b32 vcc_lo, 2
  s_cbranch_scc0 L_s69
  s_waitcnt vmcnt(3)
L_s69:
  buffer_load_dwordx4 v[120:123], v138, s[32:35], s57 offen offset:256 nt
  v_fma_f32 v69, v152, s61, -v66
  v_exp_f32 v69, v69
  v_mov_b32 v152, v168
  v_mov_b32 v168, v184
  v_mov_b32 v184, v200
  s_waitcnt vmcnt(7)
  s_cbranch_vccz L_s70
  s_waitcnt vmcnt(5)
  s_bitcmp1_b32 vcc_lo, 1
  s_cbranch_scc0 L_s70
  s_waitcnt vmcnt(4)
L_s70:
  buffer_load_dwordx4 v[124:127], v139, s[32:35], s57 offen offset:0 nt
  v_add_f32 v65, v65, v69
  v_cvt_pk_bf16_f32 v69, v69, v69
  v_and_b32 v8, v69, v4
  v_and_b32 v9, v69, v5
  v_and_b32 v10, v69, v6
  v_and_b32 v11, v69, v7
  s_waitcnt vmcnt(7)
  s_cbranch_vccz L_s71
  s_waitcnt vmcnt(5)
  s_bitcmp1_b32 vcc_lo, 1
  s_cbranch_scc0 L_s71
  s_waitcnt vmcnt(4)
L_s71:
  buffer_load_dwordx4 v[128:131], v139, s[32:35], s57 offen offset:128 nt
  v_mfma_f32_16x16x32_bf16 v[16:19], v[8:11], v[88:91], v[16:19]
  v_mfma_f32_16x16x32_bf16 v[20:23], v[8:11], v[92:95], v[20:23]
  v_mfma_f32_16x16x32_bf16 v[24:27], v[8:11], v[96:99], v[24:27]
  s_cmp_lg_u32 s59, 15
  s_cbranch_scc1 L_x72
  s_cmp_lg_u32 s54, 0
  s_cbranch_scc1 L_x72
  s_mul_i32 s63, s81, 11
  s_add_u32 s63, s63, s30
  s_and_b32 s63, s63, 31
  s_lshl_b32 s63, s63, 11
  s_add_u32 s63, s63, 3145728
  s_mov_b32 s80, 1
  s_atomic_add s80, s[28:29], s63 glc
L_x72:
  s_waitcnt vmcnt(7)
  s_cbranch_vccz L_s73
  s_waitcnt vmcnt(5)
  s_bitcmp1_b32 vcc_lo, 1
  s_cbranch_scc0 L_s73
  s_waitcnt vmcnt(4)
L_s73:
  buffer_load_dwordx4 v[132:135], v139, s[32:35], s57 offen offset:256 nt
  v_fma_f32 v69, v153, s61, -v66
  v_exp_f32 v69, v69
  v_mov_b32 v153, v169
  v_mov_b32 v169, v185
  v_mov_b32 v185, v201
  s_waitcnt vmcnt(7)
  s_cbranch_vccz L_s74
  s_waitcnt vmcnt(5)
  s_bitcmp1_b32 vcc_lo, 1
  s_cbranch_scc0 L_s74
  s_waitcnt vmcnt(4)
L_s74:
  buffer_load_dwordx4 v[88:91], v140, s[32:35], s57 offen offset:0 nt
  v_add_f32 v65, v65, v69
  v_cvt_pk_bf16_f32 v69, v69, v69
  v_and_b32 v12, v69, v4
  v_and_b32 v13, v69, v5
  v_and_b32 v14, v69, v6
  v_and_b32 v15, v69, v7
  s_waitcnt vmcnt(7)
  s_cbranch_vccz L_s75
  s_waitcnt vmcnt(5)
  s_bitcmp1_b32 vcc_lo, 1
  s_cbranch_scc0 L_s75
  s_waitcnt vmcnt(4)
L_s75:
  buffer_load_dwordx4 v[92:95], v140, s[32:35], s57 offen offset:128 nt
  v_mfma_f32_16x16x32_bf16 v[16:19], v[12:15], v[100:103], v[16:19]
  v_mfma_f32_16x16x32_bf16 v[20:23], v[12:15], v[104:107], v[20:23]
  v_mfma_f32_16x16x32_bf16 v[24:27], v[12:15], v[108:111], v[24:27]
  s_waitcnt vmcnt(7)
  s_cbranch_vccz L_s76
  s_waitcnt vmcnt(5)
  s_bitcmp1_b32 vcc_lo, 1
  s_cbranch_scc0 L_s76
  s_waitcnt vmcnt(4)
  s_bitcmp1_b32 vcc_lo, 2
  s_cbranch_scc0 L_s76
  s_waitcnt vmcnt(3)
L_s76:
  buffer_load_dwordx4 v[96:99], v140, s[32:35], s57 offen offset:256 nt
  v_fma_f32 v69, v154, s61, -v66
  v_exp_f32 v69, v69
  v_mov_b32 v154, v170
  v_mov_b32 v170, v186
  v_mov_b32 v186, v202
  s_cmp_eq_u32 s4, 5
  s_cselect_b32 s63, 66846720, 0
  s_add_u32 s57, s57, s63
  s_waitcnt vmcnt(7)
  s_cbranch_vccz L_s77
  s_waitcnt vmcnt(5)
  s_bitcmp1_b32 vcc_lo, 1
  s_cbranch_scc0 L_s77
  s_waitcnt vmcnt(4)
L_s77:
  buffer_load_dwordx4 v[100:103], v141, s[32:35], s57 offen offset:0 nt
  v_add_f32 v65, v65, v69
  v_cvt_pk_bf16_f32 v69, v69, v69
  v_and_b32 v8, v69, v4
  v_and_b32 v9, v69, v5
  v_and_b32 v10, v69, v6
  v_and_b32 v11, v69, v7
  s_waitcnt vmcnt(7)
  s_cbranch_vccz L_s78
  s_waitcnt vmcnt(5)
  s_bitcmp1_b32 vcc_lo, 1
  s_cbranch_scc0 L_s78
  s_waitcnt vmcnt(4)
L_s78:
  buffer_load_dwordx4 v[104:107], v141, s[32:35], s57 offen offset:128 nt
  v_mfma_f32_16x16x32_bf16 v[16:19], v[8:11], v[112:115], v[16:19]
  v_mfma_f32_16x16x32_bf16 v[20:23], v[8:11], v[116:119], v[20:23]
  v_mfma_f32_16x16x32_bf16 v[24:27], v[8:11], v[120:123], v[24:27]
  s_cmp_lg_u32 s59, 15
  s_cbranch_scc1 L_x79
  s_cmp_lg_u32 s54, 0
  s_cbranch_scc1 L_x79
  s_waitcnt lgkmcnt(0)
  s_sub_u32 s80, s80, s60
  s_cmp_lt_u32 s80, 8
  s_cselect_b32 s63, 1, 3
  s_cmp_lt_u32 s80, 6
  s_cselect_b32 s63, 3, s63
  s_cmp_le_u32 s80, 1
  s_cselect_b32 s63, 7, s63
  s_cmp_eq_u32 s80, 7
  s_cselect_b32 s63, 0, s63
  v_mov_b32 v2, s63
  ds_write_b32 v1, v2
L_x79:
  s_waitcnt vmcnt(7)
  s_cbranch_vccz L_s80
  s_waitcnt vmcnt(5)
  s_bitcmp1_b32 vcc_lo, 1
  s_cbranch_scc0 L_s80
  s_waitcnt vmcnt(4)
L_s80:
  buffer_load_dwordx4 v[108:111], v141, s[32:35], s57 offen offset:256 nt
  v_fma_f32 v69, v155, s61, -v66
  v_exp_f32 v69, v69
  v_mov_b32 v155, v171
  v_mov_b32 v171, v187
  v_mov_b32 v187, v203
  s_cmp_lg_u32 s59, 15
  s_cbranch_scc1 L_x81
  ds_read_b32 v2, v1
L_x81:
  s_cmp_eq_u32 s4, 6
  s_cselect_b32 s63, 66846720, 0
  s_add_u32 s57, s57, s63
  s_waitcnt vmcnt(7)
  s_cbranch_vccz L_s82
  s_waitcnt vmcnt(5)
  s_bitcmp1_b32 vcc_lo, 1
  s_cbranch_scc0 L_s82
  s_waitcnt vmcnt(4)
L_s82:
  buffer_load_dwordx4 v[112:115], v142, s[32:35], s57 offen offset:0 nt
  v_add_f32 v65, v65, v69
  v_cvt_pk_bf16_f32 v69, v69, v69
  s_cmp_lg_u32 s59, 15
  s_cbranch_scc1 L_x83
  s_waitcnt lgkmcnt(0)
  v_readfirstlane_b32 s22, v2
  s_nop 3
  s_mov_b32 vcc_lo, s22
  s_and_b64 vcc, vcc, 7
L_x83:
  v_and_b32 v12, v69, v4
  v_and_b32 v13, v69, v5
  v_and_b32 v14, v69, v6
  v_and_b32 v15, v69, v7
  s_waitcnt vmcnt(7)
  s_cbranch_vccz L_s84
  s_waitcnt vmcnt(5)
  s_bitcmp1_b32 vcc_lo, 1
  s_cbranch_scc0 L_s84
  s_waitcnt vmcnt(4)
L_s84:
  buffer_load_dwordx4 v[116:119], v142, s[32:35], s57 offen offset:128 nt
  v_mfma_f32_16x16x32_bf16 v[16:19], v[12:15], v[124:127], v[16:19]
  v_mfma_f32_16x16x32_bf16 v[20:23], v[12:15], v[128:131], v[20:23]
  v_mfma_f32_16x16x32_bf16 v[24:27], v[12:15], v[132:135], v[24:27]
  s_barrier
  s_lshr_b32 s63, s22, 5
  s_cmp_eq_u32 s63, 3
  s_cselect_b32 s22, 3, s22
  s_mov_b32 vcc_lo, s22
  s_and_b64 vcc, vcc, 7
  s_waitcnt vmcnt(7)
  s_cbranch_vccz L_s85
  s_waitcnt vmcnt(5)
  s_bitcmp1_b32 vcc_lo, 1
  s_cbranch_scc0 L_s85
  s_waitcnt vmcnt(4)
  s_bitcmp1_b32 vcc_lo, 2
  s_cbranch_scc0 L_s85
  s_waitcnt vmcnt(3)
L_s85:
  buffer_load_dwordx4 v[120:123], v142, s[32:35], s57 offen offset:256 nt
  v_fma_f32 v69, v156, s61, -v66
  v_exp_f32 v69, v69
  v_mov_b32 v156, v172
  v_mov_b32 v172, v188
  v_mov_b32 v188, v204
  s_cmp_lg_u32 s59, 15
  s_cbranch_scc1 L_x86
  ds_read_b32 v2, v1
L_x86:
  s_waitcnt vmcnt(7)
  s_cbranch_vccz L_s87
  s_waitcnt vmcnt(5)
  s_bitcmp1_b32 vcc_lo, 1
  s_cbranch_scc0 L_s87
  s_waitcnt vmcnt(4)
L_s87:
  buffer_load_dwordx4 v[124:127], v143, s[32:35], s57 offen offset:0 nt
  v_add_f32 v65, v65, v69
  v_cvt_pk_bf16_f32 v69, v69, v69
  s_cmp_lg_u32 s59, 15
  s_cbranch_scc1 L_x88
  s_waitcnt lgkmcnt(0)
  v_readfirstlane_b32 s22, v2
  s_nop 3
  s_mov_b32 vcc_lo, s22
  s_and_b64 vcc, vcc, 7
L_x88:
  v_and_b32 v8, v69, v4
  v_and_b32 v9, v69, v5
  v_and_b32 v10, v69, v6
  v_and_b32 v11, v69, v7
  s_waitcnt vmcnt(7)
  s_cbranch_vccz L_s89
  s_waitcnt vmcnt(5)
  s_bitcmp1_b32 vcc_lo, 1
  s_cbranch_scc0 L_s89
  s_waitcnt vmcnt(4)
L_s89:
  buffer_load_dwordx4 v[128:131], v143, s[32:35], s57 offen offset:128 nt
  v_mfma_f32_16x16x32_bf16 v[16:19], v[8:11], v[88:91], v[16:19]
  v_mfma_f32_16x16x32_bf16 v[20:23], v[8:11], v[92:95], v[20:23]
  v_mfma_f32_16x16x32_bf16 v[24:27], v[8:11], v[96:99], v[24:27]
  s_cmp_eq_u32 s4, 5
  s_cbranch_scc0 L_n90
  s_waitcnt vmcnt(7)
  s_cbranch_vccz L_s91
  s_waitcnt vmcnt(6)
  s_bitcmp1_b32 vcc_lo, 1
  s_cbranch_scc0 L_s91
  s_waitcnt vmcnt(5)
L_s91:
  s_branch L_t90
L_n90:
  s_waitcnt vmcnt(7)
  s_cbranch_vccz L_s92
  s_waitcnt vmcnt(5)
  s_bitcmp1_b32 vcc_lo, 1
  s_cbranch_scc0 L_s92
  s_waitcnt vmcnt(4)
L_s92:
L_t90:
  buffer_load_dwordx4 v[132:135], v143, s[32:35], s57 offen offset:256 nt
  s_cmp_lg_u32 s4, 5
  s_cbranch_scc1 L_eV5
  v_add_f32_dpp v65, v65, v65 row_ror:8 row_mask:0xf bank_mask:0xf
  s_nop 1
  v_add_f32_dpp v65, v65, v65 row_bcast:15 row_mask:0xa bank_mask:0xf
  s_nop 1
  v_add_f32_dpp v65, v65, v65 row_bcast:31 row_mask:0xc bank_mask:0xf
  s_nop 1
  s_mov_b64 exec, s[66:67]
  ds_write_b128 v218, v[16:19] offset:0
  ds_write_b128 v218, v[20:23] offset:256
  ds_write_b128 v218, v[24:27] offset:512
  s_mov_b32 exec_lo, 0
  s_mov_b32 exec_hi, 0x80000000
  ds_write_b32 v220, v67
  ds_write_b32 v220, v65 offset:16
  s_mov_b64 exec, -1
  s_waitcnt lgkmcnt(0)
  v_add_u32 v218, 6144, v218
  v_add_u32 v220, 32, v220
  v_mov_b32 v67, v68
  v_mov_b32 v68, v216
  v_mov_b32 v16, 0
  v_mov_b32 v17, 0
  v_mov_b32 v18, 0
  v_mov_b32 v19, 0
  v_mov_b32 v20, 0
  v_mov_b32 v21, 0
  v_mov_b32 v22, 0
  v_mov_b32 v23, 0
  v_mov_b32 v24, 0
  v_mov_b32 v25, 0
  v_mov_b32 v26, 0
  v_mov_b32 v27, 0
  v_mov_b32 v65, 0
  v_mul_f32 v66, s61, v67
L_eV5:
  v_fma_f32 v69, v157, s61, -v66
  v_exp_f32 v69, v69
  v_mov_b32 v157, v173
  v_mov_b32 v173, v189
  v_mov_b32 v189, v205
  s_waitcnt vmcnt(7)
  s_cbranch_vccz L_s93
  s_waitcnt vmcnt(5)
  s_bitcmp1_b32 vcc_lo, 1
  s_cbranch_scc0 L_s93
  s_waitcnt vmcnt(4)
L_s93:
  buffer_load_dwordx4 v[88:91], v144, s[32:35], s57 offen offset:0 nt
  v_add_f32 v65, v65, v69
  v_cvt_pk_bf16_f32 v69, v69, v69
  v_and_b32 v12, v69, v4
  v_and_b32 v13, v69, v5
  v_and_b32 v14, v69, v6
  v_and_b32 v15, v69, v7
  s_waitcnt vmcnt(7)
  s_cbranch_vccz L_s94
  s_waitcnt vmcnt(5)
  s_bitcmp1_b32 vcc_lo, 1
  s_cbranch_scc0 L_s94
  s_waitcnt vmcnt(4)
L_s94:
  buffer_load_dwordx4 v[92:95], v144, s[32:35], s57 offen offset:128 nt
  v_mfma_f32_16x16x32_bf16 v[16:19], v[12:15], v[100:103], v[16:19]
  v_mfma_f32_16x16x32_bf16 v[20:23], v[12:15], v[104:107], v[20:23]
  v_mfma_f32_16x16x32_bf16 v[24:27], v[12:15], v[108:111], v[24:27]
  s_cmp_eq_u32 s4, 6
  s_cbranch_scc0 L_n95
  s_waitcnt vmcnt(7)
  s_cbranch_vccz L_s96
  s_waitcnt vmcnt(6)
  s_bitcmp1_b32 vcc_lo, 1
  s_cbranch_scc0 L_s96
  s_waitcnt vmcnt(5)
  s_bitcmp1_b32 vcc_lo, 2
  s_cbranch_scc0 L_s96
  s_waitcnt vmcnt(4)
L_s96:
  s_branch L_t95
L_n95:
  s_waitcnt vmcnt(7)
  s_cbranch_vccz L_s97
  s_waitcnt vmcnt(5)
  s_bitcmp1_b32 vcc_lo, 1
  s_cbranch_scc0 L_s97
  s_waitcnt vmcnt(4)
  s_bitcmp1_b32 vcc_lo, 2
  s_cbranch_scc0 L_s97
  s_waitcnt vmcnt(3)
L_s97:
L_t95:
  buffer_load_dwordx4 v[96:99], v144, s[32:35], s57 offen offset:256 nt
  s_cmp_lg_u32 s4, 6
  s_cbranch_scc1 L_eV6
  v_add_f32_dpp v65, v65, v65 row_ror:8 row_mask:0xf bank_mask:0xf
  s_nop 1
  v_add_f32_dpp v65, v65, v65 row_bcast:15 row_mask:0xa bank_mask:0xf
  s_nop 1
  v_add_f32_dpp v65, v65, v65 row_bcast:31 row_mask:0xc bank_mask:0xf
  s_nop 1
  s_mov_b64 exec, s[66:67]
  ds_write_b128 v218, v[16:19] offset:0
  ds_write_b128 v218, v[20:23] offset:256
  ds_write_b128 v218, v[24:27] offset:512
  s_mov_b32 exec_lo, 0
  s_mov_b32 exec_hi, 0x80000000
  ds_write_b32 v220, v67
  ds_write_b32 v220, v65 offset:16
  s_mov_b64 exec, -1
  s_waitcnt lgkmcnt(0)
  v_add_u32 v218, 6144, v218
  v_add_u32 v220, 32, v220
  v_mov_b32 v67, v68
  v_mov_b32 v68, v216
  v_mov_b32 v16, 0
  v_mov_b32 v17, 0
  v_mov_b32 v18, 0
  v_mov_b32 v19, 0
  v_mov_b32 v20, 0
  v_mov_b32 v21, 0
  v_mov_b32 v22, 0
  v_mov_b32 v23, 0
  v_mov_b32 v24, 0
  v_mov_b32 v25, 0
  v_mov_b32 v26, 0
  v_mov_b32 v27, 0
  v_mov_b32 v65, 0
  v_mul_f32 v66, s61, v67
L_eV6:
  v_fma_f32 v69, v158, s61, -v66
  v_exp_f32 v69, v69
  v_mov_b32 v158, v174
  v_mov_b32 v174, v190
  v_mov_b32 v190, v206
  s_waitcnt vmcnt(7)
  s_cbranch_vccz L_s98
  s_waitcnt vmcnt(5)
  s_bitcmp1_b32 vcc_lo, 1
  s_cbranch_scc0 L_s98
  s_waitcnt vmcnt(4)
L_s98:
  buffer_load_dwordx4 v[100:103], v145, s[32:35], s57 offen offset:0 nt
  v_add_f32 v65, v65, v69
  v_cvt_pk_bf16_f32 v69, v69, v69
  v_and_b32 v8, v69, v4
  v_and_b32 v9, v69, v5
  v_and_b32 v10, v69, v6
  v_and_b32 v11, v69, v7
  s_waitcnt vmcnt(7)
  s_cbranch_vccz L_s99
  s_waitcnt vmcnt(5)
  s_bitcmp1_b32 vcc_lo, 1
  s_cbranch_scc0 L_s99
  s_waitcnt vmcnt(4)
L_s99:
  buffer_load_dwordx4 v[104:107], v145, s[32:35], s57 offen offset:128 nt
  v_mfma_f32_16x16x32_bf16 v[16:19], v[8:11], v[112:115], v[16:19]
  v_mfma_f32_16x16x32_bf16 v[20:23], v[8:11], v[116:119], v[20:23]
  v_mfma_f32_16x16x32_bf16 v[24:27], v[8:11], v[120:123], v[24:27]
  s_waitcnt vmcnt(7)
  s_cbranch_vccz L_s100
  s_waitcnt vmcnt(5)
  s_bitcmp1_b32 vcc_lo, 1
  s_cbranch_scc0 L_s100
  s_waitcnt vmcnt(4)
L_s100:
  buffer_load_dwordx4 v[108:111], v145, s[32:35], s57 offen offset:256 nt
  v_fma_f32 v69, v159, s61, -v66
  v_exp_f32 v69, v69
  v_mov_b32 v159, v175
  v_mov_b32 v175, v191
  v_mov_b32 v191, v207
  s_cmp_eq_u32 s4, 10
  s_cselect_b32 s63, 66846720, 0
  s_add_u32 s57, s57, s63
  s_waitcnt vmcnt(7)
  s_cbranch_vccz L_s101
  s_waitcnt vmcnt(5)
  s_bitcmp1_b32 vcc_lo, 1
  s_cbranch_scc0 L_s101
  s_waitcnt vmcnt(4)
L_s101:
  buffer_load_dwordx4 v[112:115], v146, s[32:35], s57 offen offset:0 nt
  v_add_f32 v65, v65, v69
  v_cvt_pk_bf16_f32 v69, v69, v69
  v_and_b32 v12, v69, v4
  v_and_b32 v13, v69, v5
  v_and_b32 v14, v69, v6
  v_and_b32 v15, v69, v7
  s_bitcmp1_b32 s59, 0
  s_cbranch_scc0 L_n102
  s_waitcnt vmcnt(7)
  s_cbranch_vccz L_s103
  s_waitcnt vmcnt(6)
  s_bitcmp1_b32 vcc_lo, 1
  s_cbranch_scc0 L_s103
  s_waitcnt vmcnt(5)
L_s103:
  s_branch L_t102
L_n102:
  s_waitcnt vmcnt(7)
  s_cbranch_vccz L_s104
  s_waitcnt vmcnt(5)
  s_bitcmp1_b32 vcc_lo, 1
  s_cbranch_scc0 L_s104
  s_waitcnt vmcnt(4)
L_s104:
L_t102:
  buffer_load_dwordx4 v[116:119], v146, s[32:35], s57 offen offset:128 nt
  v_mfma_f32_16x16x32_bf16 v[16:19], v[12:15], v[124:127], v[16:19]
  v_mfma_f32_16x16x32_bf16 v[20:23], v[12:15], v[128:131], v[20:23]
  v_mfma_f32_16x16x32_bf16 v[24:27], v[12:15], v[132:135], v[24:27]
  s_barrier
  s_bitcmp1_b32 s59, 0
  s_cbranch_scc0 L_nored
  ds_read_b128 v[48:51], v221
  ds_read_b128 v[52:55], v221 offset:16
  ds_read2st64_b32 v[40:41], v219 offset0:0 offset1:3
  ds_read2st64_b32 v[42:43], v219 offset0:6 offset1:9
  ds_read2st64_b32 v[44:45], v219 offset0:12 offset1:15
  ds_read2st64_b32 v[46:47], v219 offset0:18 offset1:21
  s_waitcnt lgkmcnt(0)
  v_max3_f32 v56, v48, v49, v50
  v_max_f32 v56, v56, v51
  v_mul_f32 v56, s61, v56
  v_fma_f32 v48, v48, s61, -v56
  v_fma_f32 v49, v49, s61, -v56
  v_fma_f32 v50, v50, s61, -v56
  v_fma_f32 v51, v51, s61, -v56
  v_exp_f32 v48, v48
  v_exp_f32 v49, v49
  v_exp_f32 v50, v50
  v_exp_f32 v51, v51
  v_mul_f32 v57, v48, v52
  v_fmac_f32 v57, v49, v53
  v_fmac_f32 v57, v50, v54
  v_fmac_f32 v57, v51, v55
  v_rcp_f32 v58, v57
  v_log_f32 v57, v57
  s_waitcnt lgkmcnt(0)
  v_add_f32 v40, v40, v41
  v_add_f32 v42, v42, v43
  v_add_f32 v44, v44, v45
  v_add_f32 v46, v46, v47
  v_mul_f32 v40, v48, v40
  v_fmac_f32 v40, v49, v42
  v_fmac_f32 v40, v50, v44
  v_fmac_f32 v40, v51, v46
  v_add_f32 v56, v56, v57
  v_mul_f32 v40, v40, v58
  v_add_u32 v83, v56, v248
  s_nop 1
  v_mov_b32_dpp v81, v40 quad_perm:[1,1,3,3] row_mask:0xf bank_mask:0xf
  v_cvt_pk_bf16_f32 v80, v40, v81
  s_nop 1
  v_mov_b32_dpp v81, v80 row_shl:2 row_mask:0xf bank_mask:0xf
  v_mov_b32_dpp v82, v80 row_shl:4 row_mask:0xf bank_mask:0xf
  s_mov_b64 exec, s[72:73]
  buffer_store_dwordx4 v[80:83], v73, s[44:47], s31 offen sc1
  s_mov_b64 exec, -1
  s_add_u32 s31, s31, 131072
  v_add_u32 v219, 6144, v219
  v_add_u32 v221, 32, v221
L_nored:
  s_cmp_lg_u32 s54, 0
  s_cbranch_scc1 L_cV
  s_add_u32 s80, s60, 8
  s_mov_b32 s63, 65534
  s_bitcmp1_b32 s63, s59
  s_cbranch_scc0 L_cV
  s_lshl1_add_u32 s63, s59, 1
  s_mul_i32 s63, s63, s81
  s_add_u32 s63, s63, s30
  s_and_b32 s63, s63, 31
  s_lshl_b32 s63, s63, 3
  s_and_b32 s64, s59, 7
  s_add_u32 s63, s63, s64
  s_lshr_b32 s64, s59, 3
  s_lshl_b32 s64, s64, 8
  s_add_u32 s63, s63, s64
  s_lshl_b32 s63, s63, 8
  s_add_u32 s63, s63, 3145728
  s_mov_b32 s80, 1
  s_atomic_add s80, s[28:29], s63 glc
L_cV:
  s_bitcmp1_b32 s59, 0
  s_cbranch_scc0 L_n105
  s_waitcnt vmcnt(7)
  s_cbranch_vccz L_s106
  s_waitcnt vmcnt(6)
  s_bitcmp1_b32 vcc_lo, 1
  s_cbranch_scc0 L_s106
  s_waitcnt vmcnt(5)
  s_bitcmp1_b32 vcc_lo, 2
  s_cbranch_scc0 L_s106
  s_waitcnt vmcnt(4)
L_s106:
  s_branch L_t105
L_n105:
  s_waitcnt vmcnt(7)
  s_cbranch_vccz L_s107
  s_waitcnt vmcnt(5)
  s_bitcmp1_b32 vcc_lo, 1
  s_cbranch_scc0 L_s107
  s_waitcnt vmcnt(4)
  s_bitcmp1_b32 vcc_lo, 2
  s_cbranch_scc0 L_s107
  s_waitcnt vmcnt(3)
L_s107:
L_t105:
  buffer_load_dwordx4 v[120:123], v146, s[32:35], s57 offen offset:256 nt
  v_fma_f32 v69, v160, s61, -v66
  v_exp_f32 v69, v69
  v_mov_b32 v160, v176
  v_mov_b32 v176, v192
  v_mov_b32 v192, v208
  s_cmp_eq_u32 s4, 11
  s_cselect_b32 s63, 66846720, 0
  s_add_u32 s57, s57, s63
  s_bitcmp1_b32 s59, 0
  s_cbranch_scc0 L_n108
  s_waitcnt vmcnt(7)
  s_cbranch_vccz L_s109
  s_waitcnt vmcnt(6)
  s_bitcmp1_b32 vcc_lo, 1
  s_cbranch_scc0 L_s109
  s_waitcnt vmcnt(5)
L_s109:
  s_branch L_t108
L_n108:
  s_waitcnt vmcnt(7)
  s_cbranch_vccz L_s110
  s_waitcnt vmcnt(5)
  s_bitcmp1_b32 vcc_lo, 1
  s_cbranch_scc0 L_s110
  s_waitcnt vmcnt(4)
L_s110:
L_t108:
  buffer_load_dwordx4 v[124:127], v147, s[32:35], s57 offen offset:0 nt
  v_add_f32 v65, v65, v69
  v_cvt_pk_bf16_f32 v69, v69, v69
  v_and_b32 v8, v69, v4
  v_and_b32 v9, v69, v5
  v_and_b32 v10, v69, v6
  v_and_b32 v11, v69, v7
  s_bitcmp1_b32 s59, 0
  s_cbranch_scc0 L_n111
  s_waitcnt vmcnt(7)
  s_cbranch_vccz L_s112
  s_waitcnt vmcnt(6)
  s_bitcmp1_b32 vcc_lo, 1
  s_cbranch_scc0 L_s112
  s_waitcnt vmcnt(5)
L_s112:
  s_branch L_t111
L_n111:
  s_waitcnt vmcnt(7)
  s_cbranch_vccz L_s113
  s_waitcnt vmcnt(5)
  s_bitcmp1_b32 vcc_lo, 1
  s_cbranch_scc0 L_s113
  s_waitcnt vmcnt(4)
L_s113:
L_t111:
  buffer_load_dwordx4 v[128:131], v147, s[32:35], s57 offen offset:128 nt
  v_mfma_f32_16x16x32_bf16 v[16:19], v[8:11], v[88:91], v[16:19]
  v_mfma_f32_16x16x32_bf16 v[20:23], v[8:11], v[92:95], v[20:23]
  v_mfma_f32_16x16x32_bf16 v[24:27], v[8:11], v[96:99], v[24:27]
  s_bitcmp1_b32 s59, 0
  s_cbranch_scc0 L_n114
  s_waitcnt vmcnt(7)
  s_cbranch_vccz L_s115
  s_waitcnt vmcnt(6)
  s_bitcmp1_b32 vcc_lo, 1
  s_cbranch_scc0 L_s115
  s_waitcnt vmcnt(5)
L_s115:
  s_branch L_t114
L_n114:
  s_waitcnt vmcnt(7)
  s_cbranch_vccz L_s116
  s_waitcnt vmcnt(5)
  s_bitcmp1_b32 vcc_lo, 1
  s_cbranch_scc0 L_s116
  s_waitcnt vmcnt(4)
L_s116:
L_t114:
  buffer_load_dwordx4 v[132:135], v147, s[32:35], s57 offen offset:256 nt
  v_fma_f32 v69, v161, s61, -v66
  v_exp_f32 v69, v69
  v_mov_b32 v161, v177
  v_mov_b32 v177, v193
  v_mov_b32 v193, v209
  s_bitcmp1_b32 s59, 0
  s_cbranch_scc0 L_n117
  s_waitcnt vmcnt(7)
  s_cbranch_vccz L_s118
  s_waitcnt vmcnt(6)
  s_bitcmp1_b32 vcc_lo, 1
  s_cbranch_scc0 L_s118
  s_waitcnt vmcnt(5)
L_s118:
  s_branch L_t117
L_n117:
  s_waitcnt vmcnt(7)
  s_cbranch_vccz L_s119
  s_waitcnt vmcnt(5)
  s_bitcmp1_b32 vcc_lo, 1
  s_cbranch_scc0 L_s119
  s_waitcnt vmcnt(4)
L_s119:
L_t117:
  buffer_load_dwordx4 v[88:91], v148, s[32:35], s57 offen offset:0 nt
  v_add_f32 v65, v65, v69
  v_cvt_pk_bf16_f32 v69, v69, v69
  v_and_b32 v12, v69, v4
  v_and_b32 v13, v69, v5
  v_and_b32 v14, v69, v6
  v_and_b32 v15, v69, v7
  s_bitcmp1_b32 s59, 0
  s_cbranch_scc0 L_n120
  s_waitcnt vmcnt(7)
  s_cbranch_vccz L_s121
  s_waitcnt vmcnt(6)
  s_bitcmp1_b32 vcc_lo, 1
  s_cbranch_scc0 L_s121
  s_waitcnt vmcnt(5)
L_s121:
  s_branch L_t120
L_n120:
  s_waitcnt vmcnt(7)
  s_cbranch_vccz L_s122
  s_waitcnt vmcnt(5)
  s_bitcmp1_b32 vcc_lo, 1
  s_cbranch_scc0 L_s122
  s_waitcnt vmcnt(4)
L_s122:
L_t120:
  buffer_load_dwordx4 v[92:95], v148, s[32:35], s57 offen offset:128 nt
  v_mfma_f32_16x16x32_bf16 v[16:19], v[12:15], v[100:103], v[16:19]
  v_mfma_f32_16x16x32_bf16 v[20:23], v[12:15], v[104:107], v[20:23]
  v_mfma_f32_16x16x32_bf16 v[24:27], v[12:15], v[108:111], v[24:27]
  s_cmp_lg_u32 s54, 0
  s_cbranch_scc1 L_dV
  s_waitcnt lgkmcnt(0)
  s_sub_u32 s80, s80, s60
  s_mov_b32 s14, 50529031
  s_mov_b32 s15, 16867617
  s_lshl_b32 s64, s80, 3
  s_lshr_b64 s[14:15], s[14:15], s64
  s_and_b32 s14, s14, 0xff
  s_cmp_lt_u32 s80, 8
  s_cselect_b32 s63, s14, 3
  s_add_u32 s23, s23, 1
  s_sub_u32 s64, s80, 7
  s_cmp_lt_u32 s64, 1
  s_cselect_b32 s23, s23, 0
  s_cmp_ge_u32 s23, 2
  s_cselect_b32 s63, 0, s63
  v_mov_b32 v2, s63
  ds_write_b32 v1, v2
L_dV:
  s_cmp_eq_u32 s4, 10
  s_cbranch_scc0 L_n123
  s_waitcnt vmcnt(7)
  s_cbranch_vccz L_s124
  s_waitcnt vmcnt(6)
  s_bitcmp1_b32 vcc_lo, 1
  s_cbranch_scc0 L_s124
  s_waitcnt vmcnt(5)
  s_bitcmp1_b32 vcc_lo, 2
  s_cbranch_scc0 L_s124
  s_waitcnt vmcnt(4)
L_s124:
  s_branch L_t123
L_n123:
  s_waitcnt vmcnt(7)
  s_cbranch_vccz L_s125
  s_waitcnt vmcnt(5)
  s_bitcmp1_b32 vcc_lo, 1
  s_cbranch_scc0 L_s125
  s_waitcnt vmcnt(4)
  s_bitcmp1_b32 vcc_lo, 2
  s_cbranch_scc0 L_s125
  s_waitcnt vmcnt(3)
L_s125:
L_t123:
  buffer_load_dwordx4 v[96:99], v148, s[32:35], s57 offen offset:256 nt
  s_cmp_lg_u32 s4, 10
  s_cbranch_scc1 L_eV10
  v_add_f32_dpp v65, v65, v65 row_ror:8 row_mask:0xf bank_mask:0xf
  s_nop 1
  v_add_f32_dpp v65, v65, v65 row_bcast:15 row_mask:0xa bank_mask:0xf
  s_nop 1
  v_add_f32_dpp v65, v65, v65 row_bcast:31 row_mask:0xc bank_mask:0xf
  s_nop 1
  s_mov_b64 exec, s[66:67]
  ds_write_b128 v218, v[16:19] offset:0
  ds_write_b128 v218, v[20:23] offset:256
  ds_write_b128 v218, v[24:27] offset:512
  s_mov_b32 exec_lo, 0
  s_mov_b32 exec_hi, 0x80000000
  ds_write_b32 v220, v67
  ds_write_b32 v220, v65 offset:16
  s_mov_b64 exec, -1
  s_waitcnt lgkmcnt(0)
  v_add_u32 v218, 6144, v218
  v_add_u32 v220, 32, v220
  v_mov_b32 v67, v68
  v_mov_b32 v68, v216
  v_mov_b32 v16, 0
  v_mov_b32 v17, 0
  v_mov_b32 v18, 0
  v_mov_b32 v19, 0
  v_mov_b32 v20, 0
  v_mov_b32 v21, 0
  v_mov_b32 v22, 0
  v_mov_b32 v23, 0
  v_mov_b32 v24, 0
  v_mov_b32 v25, 0
  v_mov_b32 v26, 0
  v_mov_b32 v27, 0
  v_mov_b32 v65, 0
  v_mul_f32 v66, s61, v67
L_eV10:
  v_fma_f32 v69, v162, s61, -v66
  v_exp_f32 v69, v69
  v_mov_b32 v162, v178
  v_mov_b32 v178, v194
  v_mov_b32 v194, v210
  ds_read_b32 v2, v1
  s_waitcnt vmcnt(7)
  s_cbranch_vccz L_s126
  s_waitcnt vmcnt(5)
  s_bitcmp1_b32 vcc_lo, 1
  s_cbranch_scc0 L_s126
  s_waitcnt vmcnt(4)
L_s126:
  buffer_load_dwordx4 v[100:103], v149, s[32:35], s57 offen offset:0 nt
  v_add_f32 v65, v65, v69
  v_cvt_pk_bf16_f32 v69, v69, v69
  s_waitcnt lgkmcnt(0)
  v_readfirstlane_b32 s22, v2
  s_nop 3
  s_mov_b32 vcc_lo, s22
  s_and_b64 vcc, vcc, 7
  v_and_b32 v8, v69, v4
  v_and_b32 v9, v69, v5
  v_and_b32 v10, v69, v6
  v_and_b32 v11, v69, v7
  s_waitcnt vmcnt(7)
  s_cbranch_vccz L_s127
  s_waitcnt vmcnt(5)
  s_bitcmp1_b32 vcc_lo, 1
  s_cbranch_scc0 L_s127
  s_waitcnt vmcnt(4)
L_s127:
  buffer_load_dwordx4 v[104:107], v149, s[32:35], s57 offen offset:128 nt
  v_mfma_f32_16x16x32_bf16 v[16:19], v[8:11], v[112:115], v[16:19]
  v_mfma_f32_16x16x32_bf16 v[20:23], v[8:11], v[116:119], v[20:23]
  v_mfma_f32_16x16x32_bf16 v[24:27], v[8:11], v[120:123], v[24:27]
  s_cmp_eq_u32 s4, 11
  s_cbranch_scc0 L_n128
  s_waitcnt vmcnt(7)
  s_cbranch_vccz L_s129
  s_waitcnt vmcnt(6)
  s_bitcmp1_b32 vcc_lo, 1
  s_cbranch_scc0 L_s129
  s_waitcnt vmcnt(5)
L_s129:
  s_branch L_t128
L_n128:
  s_waitcnt vmcnt(7)
  s_cbranch_vccz L_s130
  s_waitcnt vmcnt(5)
  s_bitcmp1_b32 vcc_lo, 1
  s_cbranch_scc0 L_s130
  s_waitcnt vmcnt(4)
L_s130:
L_t128:
  buffer_load_dwordx4 v[108:111], v149, s[32:35], s57 offen offset:256 nt
  s_cmp_lg_u32 s4, 11
  s_cbranch_scc1 L_eV11
  v_add_f32_dpp v65, v65, v65 row_ror:8 row_mask:0xf bank_mask:0xf
  s_nop 1
  v_add_f32_dpp v65, v65, v65 row_bcast:15 row_mask:0xa bank_mask:0xf
  s_nop 1
  v_add_f32_dpp v65, v65, v65 row_bcast:31 row_mask:0xc bank_mask:0xf
  s_nop 1
  s_mov_b64 exec, s[66:67]
  ds_write_b128 v218, v[16:19] offset:0
  ds_write_b128 v218, v[20:23] offset:256
  ds_write_b128 v218, v[24:27] offset:512
  s_mov_b32 exec_lo, 0
  s_mov_b32 exec_hi, 0x80000000
  ds_write_b32 v220, v67
  ds_write_b32 v220, v65 offset:16
  s_mov_b64 exec, -1
  s_waitcnt lgkmcnt(0)
  v_add_u32 v218, 6144, v218
  v_add_u32 v220, 32, v220
  v_mov_b32 v67, v68
  v_mov_b32 v68, v216
  v_mov_b32 v16, 0
  v_mov_b32 v17, 0
  v_mov_b32 v18, 0
  v_mov_b32 v19, 0
  v_mov_b32 v20, 0
  v_mov_b32 v21, 0
  v_mov_b32 v22, 0
  v_mov_b32 v23, 0
  v_mov_b32 v24, 0
  v_mov_b32 v25, 0
  v_mov_b32 v26, 0
  v_mov_b32 v27, 0
  v_mov_b32 v65, 0
  v_mul_f32 v66, s61, v67
L_eV11:
  v_fma_f32 v69, v163, s61, -v66
  v_exp_f32 v69, v69
  v_mov_b32 v163, v179
  v_mov_b32 v179, v195
  v_mov_b32 v195, v211
  s_waitcnt vmcnt(7)
  s_cbranch_vccz L_s131
  s_waitcnt vmcnt(5)
  s_bitcmp1_b32 vcc_lo, 1
  s_cbranch_scc0 L_s131
  s_waitcnt vmcnt(4)
L_s131:
  buffer_load_dwordx4 v[112:115], v150, s[32:35], s57 offen offset:0 nt
  v_add_f32 v65, v65, v69
  v_cvt_pk_bf16_f32 v69, v69, v69
  ds_read_b32 v2, v1
  v_and_b32 v12, v69, v4
  v_and_b32 v13, v69, v5
  v_and_b32 v14, v69, v6
  v_and_b32 v15, v69, v7
  s_waitcnt vmcnt(7)
  s_cbranch_vccz L_s132
  s_waitcnt vmcnt(5)
  s_bitcmp1_b32 vcc_lo, 1
  s_cbranch_scc0 L_s132
  s_waitcnt vmcnt(4)
L_s132:
  buffer_load_dwordx4 v[116:119], v150, s[32:35], s57 offen offset:128 nt
  v_mfma_f32_16x16x32_bf16 v[16:19], v[12:15], v[124:127], v[16:19]
  v_mfma_f32_16x16x32_bf16 v[20:23], v[12:15], v[128:131], v[20:23]
  v_mfma_f32_16x16x32_bf16 v[24:27], v[12:15], v[132:135], v[24:27]
  s_barrier
  s_waitcnt lgkmcnt(0)
  v_readfirstlane_b32 s22, v2
  s_nop 3
  s_mov_b32 vcc_lo, s22
  s_and_b64 vcc, vcc, 7
  s_waitcnt vmcnt(7)
  s_cbranch_vccz L_s133
  s_waitcnt vmcnt(5)
  s_bitcmp1_b32 vcc_lo, 1
  s_cbranch_scc0 L_s133
  s_waitcnt vmcnt(4)
  s_bitcmp1_b32 vcc_lo, 2
  s_cbranch_scc0 L_s133
  s_waitcnt vmcnt(3)
L_s133:
  buffer_load_dwordx4 v[120:123], v150, s[32:35], s57 offen offset:256 nt
  v_fma_f32 v69, v164, s61, -v66
  v_exp_f32 v69, v69
  v_mov_b32 v164, v180
  v_mov_b32 v180, v196
  v_mov_b32 v196, v212
  s_waitcnt vmcnt(7)
  s_cbranch_vccz L_s134
  s_waitcnt vmcnt(5)
  s_bitcmp1_b32 vcc_lo, 1
  s_cbranch_scc0 L_s134
  s_waitcnt vmcnt(4)
L_s134:
  buffer_load_dwordx4 v[124:127], v151, s[32:35], s57 offen offset:0 nt
  v_add_f32 v65, v65, v69
  v_cvt_pk_bf16_f32 v69, v69, v69
  v_and_b32 v8, v69, v4
  v_and_b32 v9, v69, v5
  v_and_b32 v10, v69, v6
  v_and_b32 v11, v69, v7
  s_waitcnt vmcnt(7)
  s_cbranch_vccz L_s135
  s_waitcnt vmcnt(5)
  s_bitcmp1_b32 vcc_lo, 1
  s_cbranch_scc0 L_s135
  s_waitcnt vmcnt(4)
L_s135:
  buffer_load_dwordx4 v[128:131], v151, s[32:35], s57 offen offset:128 nt
  v_mfma_f32_16x16x32_bf16 v[16:19], v[8:11], v[88:91], v[16:19]
  v_mfma_f32_16x16x32_bf16 v[20:23], v[8:11], v[92:95], v[20:23]
  v_mfma_f32_16x16x32_bf16 v[24:27], v[8:11], v[96:99], v[24:27]
  s_waitcnt vmcnt(7)
  s_cbranch_vccz L_s136
  s_waitcnt vmcnt(5)
  s_bitcmp1_b32 vcc_lo, 1
  s_cbranch_scc0 L_s136
  s_waitcnt vmcnt(4)
L_s136:
  buffer_load_dwordx4 v[132:135], v151, s[32:35], s57 offen offset:256 nt
  v_fma_f32 v69, v165, s61, -v66
  v_exp_f32 v69, v69
  v_mov_b32 v165, v181
  v_mov_b32 v181, v197
  v_mov_b32 v197, v213
  s_add_u32 s63, s59, 1
  s_add_u32 s57, s57, 196608
  s_and_b32 s64, s63, 3
  s_cselect_b32 s57, s57, s58
  s_cmp_eq_u32 s63, 8
  s_cselect_b64 s[32:33], s[16:17], s[32:33]
  s_cmp_lg_u32 s63, 16
  s_cbranch_scc1 L_nosw
  s_mov_b64 s[32:33], s[12:13]
  s_mov_b32 s34, 7864320
  s_mov_b32 s57, s77
  s_and_b32 s63, s56, 1
  s_lshl_b32 s64, s63, 6
  s_lshl_b32 s63, s63, 8
  s_sub_u32 s63, 256, s63
  v_lshrrev_b32 v76, 4, v0
  v_mul_u32_u24 v77, 15360, v76
  v_and_b32 v78, 15, v0
  v_lshl_add_u32 v224, v78, 4, v77
  v_add_u32 v224, s64, v224
  v_add_u32 v225, 1280, v224
  v_add_u32 v226, 2560, v224
  v_add_u32 v227, 3840, v224
  v_add_u32 v228, 5120, v224
  v_add_u32 v229, 6400, v224
  v_add_u32 v230, 7680, v224
  v_add_u32 v231, 8960, v224
  v_add_u32 v232, 10240, v224
  v_add_u32 v233, 11520, v224
  v_add_u32 v234, 12800, v224
  v_add_u32 v235, 14080, v224
  v_bfe_u32 v78, v0, 2, 2
  v_mul_u32_u24 v78, 1280, v78
  v_add_u32 v77, v77, v78
  v_and_b32 v79, 3, v0
  v_lshl_add_u32 v77, v79, 4, v77
  v_add_u32 v236, s63, v77
  v_add_u32 v237, 5120, v236
  v_add_u32 v238, 10240, v236
  s_lshl_b32 s63, s63, 1
  v_add_u32 v74, s63, v70
  v_and_b32 v78, 8, v0
  v_lshl_add_u32 v70, v78, 5, v70
  s_lshl_b32 s64, s64, 1
  v_add_u32 v70, s64, v70
  v_lshrrev_b32 v71, 2, v72
  v_lshlrev_b32 v223, 4, v78
  v_lshl_add_u32 v223, v76, 3, v223
  v_and_b32 v78, 4, v0
  v_add_u32 v223, v223, v78
  v_lshrrev_b32 v77, 5, v0
  v_bfe_u32 v78, v0, 3, 2
  v_mul_u32_u24 v222, 196608, v77
  v_mul_u32_u24 v76, 1536, v78
  v_add3_u32 v222, v222, v76, v75
  v_and_b32 v3, 1, v0
  v_lshlrev_b32 v3, v3, v87
L_nosw:
  s_cmp_eq_u32 s59, s20
  s_cbranch_scc0 L_n137
  s_waitcnt vmcnt(7)
  s_cbranch_vccz L_s138
  s_waitcnt vmcnt(4)
  s_bitcmp1_b32 vcc_lo, 1
  s_cbranch_scc0 L_s138
  s_waitcnt vmcnt(3)
L_s138:
  s_branch L_t137
L_n137:
  s_waitcnt vmcnt(7)
  s_cbranch_vccz L_s139
  s_waitcnt vmcnt(5)
  s_bitcmp1_b32 vcc_lo, 1
  s_cbranch_scc0 L_s139
  s_waitcnt vmcnt(4)
L_s139:
L_t137:
  buffer_load_dwordx4 v[88:91], v224, s[32:35], s57 offen nt
  v_add_f32 v65, v65, v69
  v_cvt_pk_bf16_f32 v69, v69, v69
  ds_read_b32 v2, v1
  v_and_b32 v12, v69, v4
  v_and_b32 v13, v69, v5
  v_and_b32 v14, v69, v6
  v_and_b32 v15, v69, v7
  s_cmp_eq_u32 s59, s20
  s_cbranch_scc0 L_n140
  s_waitcnt vmcnt(7)
  s_cbranch_vccz L_s141
  s_waitcnt vmcnt(4)
  s_bitcmp1_b32 vcc_lo, 1
  s_cbranch_scc0 L_s141
  s_waitcnt vmcnt(3)
L_s141:
  s_branch L_t140
L_n140:
  s_waitcnt vmcnt(7)
  s_cbranch_vccz L_s142
  s_waitcnt vmcnt(5)
  s_bitcmp1_b32 vcc_lo, 1
  s_cbranch_scc0 L_s142
  s_waitcnt vmcnt(4)
L_s142:
L_t140:
  buffer_load_dwordx4 v[92:95], v225, s[32:35], s57 offen nt
  v_mfma_f32_16x16x32_bf16 v[16:19], v[12:15], v[100:103], v[16:19]
  v_mfma_f32_16x16x32_bf16 v[20:23], v[12:15], v[104:107], v[20:23]
  v_mfma_f32_16x16x32_bf16 v[24:27], v[12:15], v[108:111], v[24:27]
  s_waitcnt lgkmcnt(0)
  v_readfirstlane_b32 s22, v2
  s_nop 3
  s_mov_b32 vcc_lo, s22
  s_and_b64 vcc, vcc, 7
  s_cmp_eq_u32 s59, s20
  s_cbranch_scc0 L_n143
  s_waitcnt vmcnt(7)
  s_cbranch_vccz L_s144
  s_waitcnt vmcnt(4)
  s_bitcmp1_b32 vcc_lo, 1
  s_cbranch_scc0 L_s144
  s_waitcnt vmcnt(3)
  s_bitcmp1_b32 vcc_lo, 2
  s_cbranch_scc0 L_s144
  s_waitcnt vmcnt(2)
L_s144:
  s_branch L_t143
L_n143:
  s_waitcnt vmcnt(7)
  s_cbranch_vccz L_s145
  s_waitcnt vmcnt(5)
  s_bitcmp1_b32 vcc_lo, 1
  s_cbranch_scc0 L_s145
  s_waitcnt vmcnt(4)
  s_bitcmp1_b32 vcc_lo, 2
  s_cbranch_scc0 L_s145
  s_waitcnt vmcnt(3)
L_s145:
L_t143:
  buffer_load_dwordx4 v[96:99], v226, s[32:35], s57 offen nt
  v_fma_f32 v69, v166, s61, -v66
  v_exp_f32 v69, v69
  v_mov_b32 v166, v182
  v_mov_b32 v182, v198
  v_mov_b32 v198, v214
  s_cmp_eq_u32 s59, s20
  s_cbranch_scc0 L_n146
  s_waitcnt vmcnt(7)
  s_cbranch_vccz L_s147
  s_waitcnt vmcnt(4)
  s_bitcmp1_b32 vcc_lo, 1
  s_cbranch_scc0 L_s147
  s_waitcnt vmcnt(3)
L_s147:
  s_branch L_t146
L_n146:
  s_waitcnt vmcnt(7)
  s_cbranch_vccz L_s148
  s_waitcnt vmcnt(5)
  s_bitcmp1_b32 vcc_lo, 1
  s_cbranch_scc0 L_s148
  s_waitcnt vmcnt(4)
L_s148:
L_t146:
  buffer_load_dwordx4 v[100:103], v227, s[32:35], s57 offen nt
  v_add_f32 v65, v65, v69
  v_cvt_pk_bf16_f32 v69, v69, v69
  v_and_b32 v8, v69, v4
  v_and_b32 v9, v69, v5
  v_and_b32 v10, v69, v6
  v_and_b32 v11, v69, v7
  s_cmp_eq_u32 s59, s20
  s_cbranch_scc0 L_n149
  s_waitcnt vmcnt(7)
  s_cbranch_vccz L_s150
  s_waitcnt vmcnt(4)
  s_bitcmp1_b32 vcc_lo, 1
  s_cbranch_scc0 L_s150
  s_waitcnt vmcnt(3)
L_s150:
  s_branch L_t149
L_n149:
  s_waitcnt vmcnt(7)
  s_cbranch_vccz L_s151
  s_waitcnt vmcnt(5)
  s_bitcmp1_b32 vcc_lo, 1
  s_cbranch_scc0 L_s151
  s_waitcnt vmcnt(4)
L_s151:
L_t149:
  buffer_load_dwordx4 v[104:107], v228, s[32:35], s57 offen nt
  v_mfma_f32_16x16x32_bf16 v[16:19], v[8:11], v[112:115], v[16:19]
  v_mfma_f32_16x16x32_bf16 v[20:23], v[8:11], v[116:119], v[20:23]
  v_mfma_f32_16x16x32_bf16 v[24:27], v[8:11], v[120:123], v[24:27]
  s_bitcmp1_b32 s5, s59
  s_cbranch_scc1 L_vend
  s_cmp_eq_u32 s59, s20
  s_cbranch_scc0 L_n152
  s_waitcnt vmcnt(7)
  s_cbranch_vccz L_s153
  s_waitcnt vmcnt(4)
  s_bitcmp1_b32 vcc_lo, 1
  s_cbranch_scc0 L_s153
  s_waitcnt vmcnt(3)
L_s153:
  s_branch L_t152
L_n152:
  s_waitcnt vmcnt(7)
  s_cbranch_vccz L_s154
  s_waitcnt vmcnt(5)
  s_bitcmp1_b32 vcc_lo, 1
  s_cbranch_scc0 L_s154
  s_waitcnt vmcnt(4)
L_s154:
L_t152:
  buffer_load_dwordx4 v[108:111], v229, s[32:35], s57 offen nt
  v_fma_f32 v69, v167, s61, -v66
  v_exp_f32 v69, v69
  v_mov_b32 v167, v183
  v_mov_b32 v183, v199
  v_mov_b32 v199, v215
  s_cmp_eq_u32 s59, s20
  s_cbranch_scc0 L_n155
  s_waitcnt vmcnt(7)
  s_cbranch_vccz L_s156
  s_waitcnt vmcnt(4)
  s_bitcmp1_b32 vcc_lo, 1
  s_cbranch_scc0 L_s156
  s_waitcnt vmcnt(3)
L_s156:
  s_branch L_t155
L_n155:
  s_waitcnt vmcnt(7)
  s_cbranch_vccz L_s157
  s_waitcnt vmcnt(5)
  s_bitcmp1_b32 vcc_lo, 1
  s_cbranch_scc0 L_s157
  s_waitcnt vmcnt(4)
L_s157:
L_t155:
  buffer_load_dwordx4 v[112:115], v230, s[32:35], s57 offen nt
  v_add_f32 v65, v65, v69
  v_cvt_pk_bf16_f32 v69, v69, v69
  v_and_b32 v12, v69, v4
  v_and_b32 v13, v69, v5
  v_and_b32 v14, v69, v6
  v_and_b32 v15, v69, v7
  s_cmp_eq_u32 s59, s20
  s_cbranch_scc0 L_n158
  s_waitcnt vmcnt(7)
  s_cbranch_vccz L_s159
  s_waitcnt vmcnt(4)
  s_bitcmp1_b32 vcc_lo, 1
  s_cbranch_scc0 L_s159
  s_waitcnt vmcnt(3)
L_s159:
  s_branch L_t158
L_n158:
  s_waitcnt vmcnt(7)
  s_cbranch_vccz L_s160
  s_waitcnt vmcnt(5)
  s_bitcmp1_b32 vcc_lo, 1
  s_cbranch_scc0 L_s160
  s_waitcnt vmcnt(4)
L_s160:
L_t158:
  buffer_load_dwordx4 v[116:119], v231, s[32:35], s57 offen nt
  v_mfma_f32_16x16x32_bf16 v[16:19], v[12:15], v[124:127], v[16:19]
  v_mfma_f32_16x16x32_bf16 v[20:23], v[12:15], v[128:131], v[20:23]
  v_mfma_f32_16x16x32_bf16 v[24:27], v[12:15], v[132:135], v[24:27]
  s_add_u32 s59, s59, 1
  s_and_b32 s63, s59, 3
  s_cmp_eq_u32 s63, 1
  s_cselect_b32 s4, s26, -1
  s_cmp_eq_u32 s63, 2
  s_cselect_b32 s4, s27, s4
  s_branch L_v0
L_vend:
  v_fma_f32 v69, v167, s61, -v66
  v_exp_f32 v69, v69
  s_add_u32 s59, s59, 1
  v_add_f32 v65, v65, v69
  v_cvt_pk_bf16_f32 v69, v69, v69
  v_and_b32 v12, v69, v4
  v_and_b32 v13, v69, v5
  v_and_b32 v14, v69, v6
  v_and_b32 v15, v69, v7
  s_waitcnt vmcnt(5)
  s_nop 0
  v_mfma_f32_16x16x32_bf16 v[16:19], v[12:15], v[124:127], v[16:19]
  v_mfma_f32_16x16x32_bf16 v[20:23], v[12:15], v[128:131], v[20:23]
  v_mfma_f32_16x16x32_bf16 v[24:27], v[12:15], v[132:135], v[24:27]
  buffer_load_dwordx4 v[108:111], v229, s[32:35], s57 offen nt
  v_add_f32_dpp v65, v65, v65 row_ror:8 row_mask:0xf bank_mask:0xf
  s_nop 1
  v_add_f32_dpp v65, v65, v65 row_bcast:15 row_mask:0xa bank_mask:0xf
  s_nop 1
  v_add_f32_dpp v65, v65, v65 row_bcast:31 row_mask:0xc bank_mask:0xf
  s_nop 1
  s_mov_b64 exec, s[66:67]
  ds_write_b128 v218, v[16:19] offset:0
  ds_write_b128 v218, v[20:23] offset:256
  ds_write_b128 v218, v[24:27] offset:512
  s_mov_b32 exec_lo, 0
  s_mov_b32 exec_hi, 0x80000000
  ds_write_b32 v220, v67
  ds_write_b32 v220, v65 offset:16
  s_mov_b64 exec, -1
  buffer_load_dwordx4 v[112:115], v230, s[32:35], s57 offen nt
  s_waitcnt lgkmcnt(0)
  v_add_u32 v218, 6144, v218
  v_add_u32 v220, 32, v220
  s_barrier
  ds_read_b128 v[48:51], v221
  ds_read_b128 v[52:55], v221 offset:16
  ds_read2st64_b32 v[40:41], v219 offset0:0 offset1:3
  ds_read2st64_b32 v[42:43], v219 offset0:6 offset1:9
  ds_read2st64_b32 v[44:45], v219 offset0:12 offset1:15
  ds_read2st64_b32 v[46:47], v219 offset0:18 offset1:21
  buffer_load_dwordx4 v[116:119], v231, s[32:35], s57 offen nt
  s_waitcnt lgkmcnt(4)
  v_max3_f32 v56, v48, v49, v50
  v_max_f32 v56, v56, v51
  v_mul_f32 v56, s61, v56
  v_fma_f32 v48, v48, s61, -v56
  v_fma_f32 v49, v49, s61, -v56
  v_fma_f32 v50, v50, s61, -v56
  v_fma_f32 v51, v51, s61, -v56
  v_exp_f32 v48, v48
  v_exp_f32 v49, v49
  v_exp_f32 v50, v50
  v_exp_f32 v51, v51
  v_mul_f32 v57, v48, v52
  v_fmac_f32 v57, v49, v53
  v_fmac_f32 v57, v50, v54
  v_fmac_f32 v57, v51, v55
  v_rcp_f32 v58, v57
  v_log_f32 v57, v57
  buffer_load_dwordx4 v[120:123], v232, s[32:35], s57 offen nt
  s_waitcnt lgkmcnt(0)
  v_add_f32 v40, v40, v41
  v_add_f32 v42, v42, v43
  v_add_f32 v44, v44, v45
  v_add_f32 v46, v46, v47
  v_mul_f32 v40, v48, v40
  v_fmac_f32 v40, v49, v42
  v_fmac_f32 v40, v50, v44
  v_fmac_f32 v40, v51, v46
  v_add_f32 v56, v56, v57
  v_mul_f32 v40, v40, v58
  v_add_u32 v83, v56, v248
  s_nop 1
  v_mov_b32_dpp v81, v40 quad_perm:[1,1,3,3] row_mask:0xf bank_mask:0xf
  v_cvt_pk_bf16_f32 v80, v40, v81
  s_nop 1
  v_mov_b32_dpp v81, v80 row_shl:2 row_mask:0xf bank_mask:0xf
  v_mov_b32_dpp v82, v80 row_shl:4 row_mask:0xf bank_mask:0xf
  s_mov_b64 exec, s[72:73]
  buffer_store_dwordx4 v[80:83], v73, s[44:47], s31 offen sc1
  s_mov_b64 exec, -1
  s_add_u32 s31, s31, 131072
  v_add_u32 v219, 6144, v219
  v_add_u32 v221, 32, v221
  s_cmp_eq_u32 s59, 8
  s_cbranch_scc1 L_kB
  s_lshl_b32 s65, s55, 6
  s_add_u32 s65, s65, s52
  s_mul_i32 s63, s65, 6144
  s_lshl_b32 s64, s54, 7
  s_add_u32 s64, s64, s63
  s_add_u32 s64, s64, 528384
  s_mov_b32 s76, 1000000
  s_mov_b32 s70, 0x000f000f
  s_mov_b32 s71, 0x000f000f
  s_cmp_lt_u32 s65, 74
  s_cbranch_scc1 L_early
  buffer_load_dwordx4 v[124:127], v233, s[32:35], s57 offen nt
  buffer_load_dwordx4 v[128:131], v234, s[32:35], s57 offen nt
  buffer_load_dwordx4 v[132:135], v235, s[32:35], s57 offen nt
  s_waitcnt vmcnt(12)
  buffer_load_dwordx4 v[152:155], v236, s[32:35], s57 offen
  s_waitcnt vmcnt(12)
  buffer_load_dwordx4 v[156:159], v237, s[32:35], s57 offen
  s_waitcnt vmcnt(12)
  buffer_load_dwordx4 v[160:163], v238, s[32:35], s57 offen
  s_waitcnt vmcnt(5)
  buffer_load_dwordx4 v[196:199], v222, s[44:47], s64 offen offset:0 sc1
  buffer_load_dwordx4 v[200:203], v222, s[44:47], s64 offen offset:512 sc1
  buffer_load_dwordx4 v[204:207], v222, s[44:47], s64 offen offset:1024 sc1
  s_waitcnt vmcnt(0)
  s_branch L_chk
L_early:
  buffer_load_dwordx4 v[196:199], v222, s[44:47], s64 offen offset:0 sc1
  buffer_load_dwordx4 v[200:203], v222, s[44:47], s64 offen offset:512 sc1
  buffer_load_dwordx4 v[204:207], v222, s[44:47], s64 offen offset:1024 sc1
  s_waitcnt vmcnt(10)
  buffer_load_dwordx4 v[124:127], v233, s[32:35], s57 offen nt
  s_waitcnt vmcnt(10)
  buffer_load_dwordx4 v[128:131], v234, s[32:35], s57 offen nt
  s_waitcnt vmcnt(10)
  buffer_load_dwordx4 v[132:135], v235, s[32:35], s57 offen nt
  s_waitcnt vmcnt(10)
  buffer_load_dwordx4 v[152:155], v236, s[32:35], s57 offen
  s_waitcnt vmcnt(10)
  buffer_load_dwordx4 v[156:159], v237, s[32:35], s57 offen
  s_waitcnt vmcnt(10)
  buffer_load_dwordx4 v[160:163], v238, s[32:35], s57 offen
  s_waitcnt vmcnt(6)
L_chk:
  v_sub_u32 v58, v199, v3
  v_sub_u32 v59, v203, v3
  v_sub_u32 v60, v207, v3
  v_xor_b32_dpp v76, v58, v58 quad_perm:[1,0,3,2] row_mask:0xf bank_mask:0xf
  v_xor_b32_dpp v77, v59, v59 quad_perm:[1,0,3,2] row_mask:0xf bank_mask:0xf
  v_xor_b32_dpp v78, v60, v60 quad_perm:[1,0,3,2] row_mask:0xf bank_mask:0xf
  v_or3_b32 v76, v76, v77, v78
  v_cmp_ne_u32 vcc, 0, v76
  s_cbranch_vccnz L_oretry
L_ook:
  v_max3_f32 v76, v58, v59, v60
  v_lshlrev_b32 v40, 16, v196
  v_and_b32 v41, s3, v196
  v_max_f32_dpp v76, v76, v76 row_ror:8 row_mask:0xf bank_mask:0xf
  v_mov_b32 v77, v76
  v_lshlrev_b32 v42, 16, v197
  v_and_b32 v43, s3, v197
  v_permlane16_swap_b32 v76, v77
  v_max_f32 v76, v76, v77
  v_sub_f32 v58, v58, v76
  v_sub_f32 v59, v59, v76
  v_sub_f32 v60, v60, v76
  v_exp_f32 v58, v58
  v_exp_f32 v59, v59
  v_exp_f32 v60, v60
  v_lshlrev_b32 v44, 16, v198
  v_and_b32 v45, s3, v198
  v_add_f32 v76, v58, v59
  v_add_f32 v76, v76, v60
  v_lshlrev_b32 v46, 16, v200
  v_and_b32 v47, s3, v200
  v_add_f32_dpp v76, v76, v76 row_ror:8 row_mask:0xf bank_mask:0xf
  v_mov_b32 v77, v76
  v_lshlrev_b32 v48, 16, v201
  v_and_b32 v49, s3, v201
  v_permlane16_swap_b32 v76, v77
  v_add_f32 v76, v76, v77
  v_rcp_f32 v76, v76
  v_lshlrev_b32 v50, 16, v202
  v_and_b32 v51, s3, v202
  v_lshlrev_b32 v52, 16, v204
  v_and_b32 v53, s3, v204
  v_lshlrev_b32 v54, 16, v205
  v_and_b32 v55, s3, v205
  v_lshlrev_b32 v56, 16, v206
  v_and_b32 v57, s3, v206
  v_mul_f32 v40, v58, v40
  v_mul_f32 v41, v58, v41
  v_mul_f32 v42, v58, v42
  v_mul_f32 v43, v58, v43
  v_mul_f32 v44, v58, v44
  v_mul_f32 v45, v58, v45
  v_fmac_f32 v40, v59, v46
  v_fmac_f32 v41, v59, v47
  v_fmac_f32 v42, v59, v48
  v_fmac_f32 v43, v59, v49
  v_fmac_f32 v44, v59, v50
  v_fmac_f32 v45, v59, v51
  v_fmac_f32 v40, v60, v52
  v_fmac_f32 v41, v60, v53
  v_fmac_f32 v42, v60, v54
  v_fmac_f32 v43, v60, v55
  v_fmac_f32 v44, v60, v56
  v_fmac_f32 v45, v60, v57
  v_add_f32_dpp v40, v40, v40 row_ror:8 row_mask:0xf bank_mask:0xf
  v_add_f32_dpp v41, v41, v41 row_ror:8 row_mask:0xf bank_mask:0xf
  v_add_f32_dpp v42, v42, v42 row_ror:8 row_mask:0xf bank_mask:0xf
  v_add_f32_dpp v43, v43, v43 row_ror:8 row_mask:0xf bank_mask:0xf
  v_add_f32_dpp v44, v44, v44 row_ror:8 row_mask:0xf bank_mask:0xf
  v_add_f32_dpp v45, v45, v45 row_ror:8 row_mask:0xf bank_mask:0xf
  v_permlane16_swap_b32 v40, v43
  v_permlane16_swap_b32 v41, v44
  v_permlane16_swap_b32 v42, v45
  v_add_f32 v40, v40, v43
  v_add_f32 v41, v41, v44
  v_add_f32 v42, v42, v45
  v_mul_f32 v40, v76, v40
  v_mul_f32 v41, v76, v41
  v_mul_f32 v42, v76, v42
  v_cvt_pk_bf16_f32 v46, v40, v40
  v_cvt_pk_bf16_f32 v47, v41, v41
  v_cvt_pk_bf16_f32 v48, v42, v42
  ds_bpermute_b32 v40, v223, v46 offset:0
  ds_bpermute_b32 v41, v223, v47 offset:0
  ds_bpermute_b32 v42, v223, v48 offset:0
  ds_bpermute_b32 v43, v223, v46 offset:64
  ds_bpermute_b32 v44, v223, v47 offset:64
  ds_bpermute_b32 v45, v223, v48 offset:64
  s_waitcnt lgkmcnt(5)
  v_and_b32 v224, v40, v4
  v_and_b32 v225, v40, v5
  v_and_b32_dpp v226, v40, v6 row_half_mirror row_mask:0xf bank_mask:0xf
  v_and_b32_dpp v227, v40, v7 row_half_mirror row_mask:0xf bank_mask:0xf
  s_waitcnt lgkmcnt(4)
  v_and_b32 v228, v41, v4
  v_and_b32 v229, v41, v5
  v_and_b32_dpp v230, v41, v6 row_half_mirror row_mask:0xf bank_mask:0xf
  v_and_b32_dpp v231, v41, v7 row_half_mirror row_mask:0xf bank_mask:0xf
  v_mfma_f32_16x16x32_bf16 v[16:19], v[224:227], v[88:91], 0
  s_waitcnt lgkmcnt(3)
  v_and_b32 v232, v42, v4
  v_and_b32 v233, v42, v5
  v_and_b32_dpp v234, v42, v6 row_half_mirror row_mask:0xf bank_mask:0xf
  v_and_b32_dpp v235, v42, v7 row_half_mirror row_mask:0xf bank_mask:0xf
  v_mfma_f32_16x16x32_bf16 v[16:19], v[228:231], v[92:95], v[16:19]
  s_waitcnt lgkmcnt(2)
  v_and_b32 v236, v43, v4
  v_and_b32 v237, v43, v5
  v_and_b32_dpp v238, v43, v6 row_half_mirror row_mask:0xf bank_mask:0xf
  v_and_b32_dpp v239, v43, v7 row_half_mirror row_mask:0xf bank_mask:0xf
  v_mfma_f32_16x16x32_bf16 v[16:19], v[232:235], v[96:99], v[16:19]
  s_waitcnt lgkmcnt(1)
  v_and_b32 v240, v44, v4
  v_and_b32 v241, v44, v5
  v_and_b32_dpp v242, v44, v6 row_half_mirror row_mask:0xf bank_mask:0xf
  v_and_b32_dpp v243, v44, v7 row_half_mirror row_mask:0xf bank_mask:0xf
  v_mfma_f32_16x16x32_bf16 v[16:19], v[236:239], v[100:103], v[16:19]
  s_waitcnt lgkmcnt(0)
  v_and_b32 v244, v45, v4
  v_and_b32 v245, v45, v5
  v_and_b32_dpp v246, v45, v6 row_half_mirror row_mask:0xf bank_mask:0xf
  v_and_b32_dpp v247, v45, v7 row_half_mirror row_mask:0xf bank_mask:0xf
  v_mfma_f32_16x16x32_bf16 v[16:19], v[240:243], v[104:107], v[16:19]
  v_and_b32_dpp v136, v40, v4 row_half_mirror row_mask:0xf bank_mask:0xf
  v_and_b32_dpp v137, v40, v5 row_half_mirror row_mask:0xf bank_mask:0xf
  v_and_b32 v138, v40, v6
  v_and_b32 v139, v40, v7
  v_mfma_f32_16x16x32_bf16 v[16:19], v[244:247], v[108:111], v[16:19]
  v_and_b32_dpp v140, v41, v4 row_half_mirror row_mask:0xf bank_mask:0xf
  v_and_b32_dpp v141, v41, v5 row_half_mirror row_mask:0xf bank_mask:0xf
  v_and_b32 v142, v41, v6
  v_and_b32 v143, v41, v7
  v_mfma_f32_16x16x32_bf16 v[16:19], v[136:139], v[112:115], v[16:19]
  v_and_b32_dpp v144, v42, v4 row_half_mirror row_mask:0xf bank_mask:0xf
  v_and_b32_dpp v145, v42, v5 row_half_mirror row_mask:0xf bank_mask:0xf
  v_and_b32 v146, v42, v6
  v_and_b32 v147, v42, v7
  v_mfma_f32_16x16x32_bf16 v[16:19], v[140:143], v[116:119], v[16:19]
  v_and_b32_dpp v148, v43, v4 row_half_mirror row_mask:0xf bank_mask:0xf
  v_and_b32_dpp v149, v43, v5 row_half_mirror row_mask:0xf bank_mask:0xf
  v_and_b32 v150, v43, v6
  v_and_b32 v151, v43, v7
  v_mfma_f32_16x16x32_bf16 v[16:19], v[144:147], v[120:123], v[16:19]
  v_and_b32_dpp v8, v44, v4 row_half_mirror row_mask:0xf bank_mask:0xf
  v_and_b32_dpp v9, v44, v5 row_half_mirror row_mask:0xf bank_mask:0xf
  v_and_b32 v10, v44, v6
  v_and_b32 v11, v44, v7
  s_waitcnt vmcnt(5)
  v_mfma_f32_16x16x32_bf16 v[16:19], v[148:151], v[124:127], v[16:19]
  v_and_b32_dpp v12, v45, v4 row_half_mirror row_mask:0xf bank_mask:0xf
  v_and_b32_dpp v13, v45, v5 row_half_mirror row_mask:0xf bank_mask:0xf
  v_and_b32 v14, v45, v6
  v_and_b32 v15, v45, v7
  s_waitcnt vmcnt(4)
  v_mfma_f32_16x16x32_bf16 v[16:19], v[8:11], v[128:131], v[16:19]
  s_nop 1
  s_waitcnt vmcnt(3)
  v_mfma_f32_16x16x32_bf16 v[16:19], v[12:15], v[132:135], v[16:19]
  s_waitcnt vmcnt(2)
  v_mfma_f32_16x16x32_bf16 v[20:23], v[224:227], v[152:155], 0
  v_mfma_f32_16x16x32_bf16 v[24:27], v[228:231], v[152:155], 0
  v_mfma_f32_16x16x32_bf16 v[28:31], v[232:235], v[152:155], 0
  v_mfma_f32_16x16x32_bf16 v[32:35], v[236:239], v[152:155], 0
  s_waitcnt vmcnt(1)
  v_mfma_f32_16x16x32_bf16 v[20:23], v[240:243], v[156:159], v[20:23]
  v_mfma_f32_16x16x32_bf16 v[24:27], v[244:247], v[156:159], v[24:27]
  v_mfma_f32_16x16x32_bf16 v[28:31], v[136:139], v[156:159], v[28:31]
  v_mfma_f32_16x16x32_bf16 v[32:35], v[140:143], v[156:159], v[32:35]
  s_waitcnt vmcnt(0)
  v_mfma_f32_16x16x32_bf16 v[20:23], v[144:147], v[160:163], v[20:23]
  v_mfma_f32_16x16x32_bf16 v[24:27], v[148:151], v[160:163], v[24:27]
  v_mfma_f32_16x16x32_bf16 v[28:31], v[8:11], v[160:163], v[28:31]
  v_mfma_f32_16x16x32_bf16 v[32:35], v[12:15], v[160:163], v[32:35]
  ds_write_b128 v70, v[16:19] offset:15360
  v_mov_b32 v81, s60
  v_mov_b32 v83, s60
  s_nop 2
  v_add_f32_dpp v20, v24, v20 row_shl:4 row_mask:0xf bank_mask:0x1
  v_add_f32_dpp v21, v25, v21 row_shl:4 row_mask:0xf bank_mask:0x1
  v_add_f32_dpp v22, v26, v22 row_shl:4 row_mask:0xf bank_mask:0x1
  v_add_f32_dpp v23, v27, v23 row_shl:4 row_mask:0xf bank_mask:0x1
  v_add_f32_dpp v20, v28, v20 row_shl:8 row_mask:0xf bank_mask:0x1
  v_add_f32_dpp v21, v29, v21 row_shl:8 row_mask:0xf bank_mask:0x1
  v_add_f32_dpp v22, v30, v22 row_shl:8 row_mask:0xf bank_mask:0x1
  v_add_f32_dpp v23, v31, v23 row_shl:8 row_mask:0xf bank_mask:0x1
  v_add_f32_dpp v20, v32, v20 row_shl:12 row_mask:0xf bank_mask:0x1
  v_add_f32_dpp v21, v33, v21 row_shl:12 row_mask:0xf bank_mask:0x1
  v_add_f32_dpp v22, v34, v22 row_shl:12 row_mask:0xf bank_mask:0x1
  v_add_f32_dpp v23, v35, v23 row_shl:12 row_mask:0xf bank_mask:0x1
  s_mov_b64 exec, s[70:71]
  ds_write_b128 v74, v[20:23] offset:15360
  s_mov_b64 exec, -1
  s_waitcnt lgkmcnt(0)
  s_barrier
  ds_read2st64_b32 v[40:41], v71 offset0:60 offset1:63
  ds_read2st64_b32 v[42:43], v71 offset0:66 offset1:69
  ds_read2st64_b32 v[44:45], v71 offset0:72 offset1:75
  ds_read2st64_b32 v[46:47], v71 offset0:78 offset1:81
  s_mov_b32 exec_hi, 0xff
  s_waitcnt lgkmcnt(2)
  v_add_f32 v40, v40, v42
  v_add_f32 v41, v41, v43
  s_waitcnt lgkmcnt(0)
  v_add_f32 v44, v44, v46
  v_add_f32 v45, v45, v47
  v_add_f32 v80, v40, v44
  v_add_f32 v82, v41, v45
  buffer_store_dwordx4 v[80:83], v72, s[44:47], s75 offen sc1
  s_mov_b64 exec, -1
  s_cmp_lg_u32 s54, 0
  s_cbranch_scc1 L_fin
  s_cmp_ge_u32 s30, 20
  s_cbranch_scc1 L_fin
  s_and_b32 s63, s2, 3
  s_mul_i32 s63, s63, 20
  s_add_u32 s63, s63, s30
  s_mul_i32 s53, s55, 80
  s_sub_u32 s53, 80, s53
  s_add_u32 s53, s53, s63
  v_lshrrev_b32 v78, 3, v0
  v_mul_u32_u24 v78, 10240, v78
  v_add_u32 v3, v78, v75
  s_cmp_ge_u32 s53, 80
  s_cselect_b32 s64, 317440, 0
  s_lshl_b32 s65, s53, 7
  s_add_u32 s64, s64, s65
  s_add_u32 s64, s64, 2101248
  s_mov_b32 s76, 1000000
  s_add_u32 s36, s64, 81920
  s_add_u32 s37, s64, 163840
  s_add_u32 s38, s64, 245760
  buffer_load_dwordx4 v[88:91], v3, s[44:47], s64 offen sc1
  buffer_load_dwordx4 v[92:95], v3, s[44:47], s36 offen sc1
  buffer_load_dwordx4 v[96:99], v3, s[44:47], s37 offen sc1
  buffer_load_dwordx4 v[100:103], v3, s[44:47], s38 offen sc1
L_ypoll:
  s_waitcnt vmcnt(0)
  v_xor_b32 v76, s60, v89
  v_xor_b32 v77, s60, v91
  v_bitop3_b32 v76, v76, v93, s60 bitop3:0xf6
  v_bitop3_b32 v77, v77, v95, s60 bitop3:0xf6
  v_bitop3_b32 v76, v76, v97, s60 bitop3:0xf6
  v_bitop3_b32 v77, v77, v99, s60 bitop3:0xf6
  v_bitop3_b32 v76, v76, v101, s60 bitop3:0xf6
  v_bitop3_b32 v77, v77, v103, s60 bitop3:0xf6
  v_or_b32 v76, v76, v77
  v_cmp_ne_u32 vcc, 0, v76
  s_cbranch_vccz L_yok0
  buffer_load_dwordx4 v[88:91], v3, s[44:47], s64 offen sc1
  buffer_load_dwordx4 v[92:95], v3, s[44:47], s36 offen sc1
  buffer_load_dwordx4 v[96:99], v3, s[44:47], s37 offen sc1
  buffer_load_dwordx4 v[100:103], v3, s[44:47], s38 offen sc1
  s_sub_u32 s76, s76, 1
  s_cbranch_scc0 L_ypoll
L_yok0:
  v_add_f32 v76, v88, v92
  v_add_f32 v77, v90, v94
  v_add_f32 v78, v96, v100
  v_add_f32 v79, v98, v102
L_yok:
  v_add_f32 v76, v76, v78
  v_add_f32 v77, v77, v79
  v_lshrrev_b32 v80, 5, v0
  v_mul_u32_u24 v80, 2560, v80
  v_permlane32_swap_b32 v76, v77
  v_lshrrev_b32 v82, 3, v75
  v_add_f32 v76, v76, v77
  v_mov_b32 v77, v76
  v_add_u32 v80, v80, v82
  s_lshl_b32 s63, s53, 4
  v_permlane16_swap_b32 v76, v77
  s_nop 0
  v_add_f32 v76, v76, v77
  s_nop 1
  v_add_f32_dpp v76, v76, v76 row_ror:8 row_mask:0xf bank_mask:0xf
  v_cvt_pk_bf16_f32 v76, v76, v76
  s_mov_b32 exec_lo, 0xff
  s_mov_b32 exec_hi, 0xff
  buffer_store_short v76, v80, s[48:51], s63 offen
  s_cmp_lg_u32 s2, 0
  s_cbranch_scc1 L_fin
  s_mov_b64 exec, 1
  v_mov_b32 v78, s0
  v_mov_b32 v79, s1
  s_mov_b32 s63, 3407868
  buffer_store_dword v78, off, s[44:47], 0
  buffer_store_dword v79, off, s[44:47], s63
L_fin:
L_end:
  s_endpgm
L_oretry:
  s_sub_u32 s76, s76, 1
  s_cbranch_scc1 L_ook
  buffer_load_dwordx4 v[196:199], v222, s[44:47], s64 offen offset:0 sc1
  buffer_load_dwordx4 v[200:203], v222, s[44:47], s64 offen offset:512 sc1
  buffer_load_dwordx4 v[204:207], v222, s[44:47], s64 offen offset:1024 sc1
  s_waitcnt vmcnt(0)
  v_sub_u32 v58, v199, v3
  v_sub_u32 v59, v203, v3
  v_sub_u32 v60, v207, v3
  v_xor_b32_dpp v76, v58, v58 quad_perm:[1,0,3,2] row_mask:0xf bank_mask:0xf
  v_xor_b32_dpp v77, v59, v59 quad_perm:[1,0,3,2] row_mask:0xf bank_mask:0xf
  v_xor_b32_dpp v78, v60, v60 quad_perm:[1,0,3,2] row_mask:0xf bank_mask:0xf
  v_or3_b32 v76, v76, v77, v78
  v_cmp_ne_u32 vcc, 0, v76
  s_cbranch_vccnz L_oretry
  s_branch L_ook
L_kB:
  ds_read_b128 v[40:43], v217 offset:0
  ds_read_b128 v[44:47], v217 offset:128
  ds_read_b128 v[48:51], v217 offset:256
  s_waitcnt lgkmcnt(0)
  v_add_u32 v217, 384, v217
  s_lshr_b32 s63, s22, 5
  s_sub_u32 s63, s63, 1
  s_cmp_lt_u32 s63, 2
  s_cselect_b32 s22, 3, s22
  s_mov_b32 vcc_lo, s22
  s_and_b64 vcc, vcc, 7
  s_waitcnt vmcnt(8)
  s_cbranch_vccz L_s167
  s_waitcnt vmcnt(6)
  s_bitcmp1_b32 vcc_lo, 1
  s_cbranch_scc0 L_s167
  s_waitcnt vmcnt(5)
L_s167:
  buffer_load_dwordx4 v[124:127], v139, s[32:35], s57 offen offset:0 nt
  s_waitcnt vmcnt(8)
  s_cbranch_vccz L_s168
  s_waitcnt vmcnt(6)
  s_bitcmp1_b32 vcc_lo, 1
  s_cbranch_scc0 L_s168
  s_waitcnt vmcnt(5)
L_s168:
  buffer_load_dwordx4 v[128:131], v139, s[32:35], s57 offen offset:128 nt
  s_waitcnt vmcnt(9)
  v_dot2_f32_bf16 v200, v88, v40, 0
  v_dot2_f32_bf16 v200, v89, v41, v200
  v_dot2_f32_bf16 v200, v90, v42, v200
  v_dot2_f32_bf16 v200, v91, v43, v200
  v_dot2_f32_bf16 v200, v92, v44, v200
  v_dot2_f32_bf16 v200, v93, v45, v200
  v_dot2_f32_bf16 v200, v94, v46, v200
  v_dot2_f32_bf16 v200, v95, v47, v200
  v_dot2_f32_bf16 v200, v96, v48, v200
  v_dot2_f32_bf16 v200, v97, v49, v200
  v_dot2_f32_bf16 v200, v98, v50, v200
  v_dot2_f32_bf16 v200, v99, v51, v200
  s_nop 2
  v_add_f32_dpp v200, v200, v200 quad_perm:[1,0,3,2] row_mask:0xf bank_mask:0xf
  s_nop 1
  v_add_f32_dpp v200, v200, v200 quad_perm:[2,3,0,1] row_mask:0xf bank_mask:0xf
  s_nop 1
  v_add_f32_dpp v200, v200, v200 row_half_mirror row_mask:0xf bank_mask:0xf
  v_max_f32 v64, v64, v200
  s_waitcnt vmcnt(8)
  s_cbranch_vccz L_s169
  s_waitcnt vmcnt(6)
  s_bitcmp1_b32 vcc_lo, 1
  s_cbranch_scc0 L_s169
  s_waitcnt vmcnt(5)
L_s169:
  buffer_load_dwordx4 v[132:135], v139, s[32:35], s57 offen offset:256 nt
  s_waitcnt vmcnt(8)
  s_cbranch_vccz L_s170
  s_waitcnt vmcnt(6)
  s_bitcmp1_b32 vcc_lo, 1
  s_cbranch_scc0 L_s170
  s_waitcnt vmcnt(5)
L_s170:
  buffer_load_dwordx4 v[88:91], v140, s[32:35], s57 offen offset:0 nt
  s_waitcnt vmcnt(8)
  s_cbranch_vccz L_s171
  s_waitcnt vmcnt(6)
  s_bitcmp1_b32 vcc_lo, 1
  s_cbranch_scc0 L_s171
  s_waitcnt vmcnt(5)
L_s171:
  buffer_load_dwordx4 v[92:95], v140, s[32:35], s57 offen offset:128 nt
  s_waitcnt vmcnt(9)
  v_dot2_f32_bf16 v201, v100, v40, 0
  v_dot2_f32_bf16 v201, v101, v41, v201
  v_dot2_f32_bf16 v201, v102, v42, v201
  v_dot2_f32_bf16 v201, v103, v43, v201
  v_dot2_f32_bf16 v201, v104, v44, v201
  v_dot2_f32_bf16 v201, v105, v45, v201
  v_dot2_f32_bf16 v201, v106, v46, v201
  v_dot2_f32_bf16 v201, v107, v47, v201
  v_dot2_f32_bf16 v201, v108, v48, v201
  v_dot2_f32_bf16 v201, v109, v49, v201
  v_dot2_f32_bf16 v201, v110, v50, v201
  v_dot2_f32_bf16 v201, v111, v51, v201
  s_nop 2
  v_add_f32_dpp v201, v201, v201 quad_perm:[1,0,3,2] row_mask:0xf bank_mask:0xf
  s_nop 1
  v_add_f32_dpp v201, v201, v201 quad_perm:[2,3,0,1] row_mask:0xf bank_mask:0xf
  s_nop 1
  v_add_f32_dpp v201, v201, v201 row_half_mirror row_mask:0xf bank_mask:0xf
  v_max_f32 v64, v64, v201
  s_waitcnt vmcnt(8)
  s_cbranch_vccz L_s172
  s_waitcnt vmcnt(6)
  s_bitcmp1_b32 vcc_lo, 1
  s_cbranch_scc0 L_s172
  s_waitcnt vmcnt(4)
L_s172:
  buffer_load_dwordx4 v[96:99], v140, s[32:35], s57 offen offset:256 nt
  s_waitcnt vmcnt(8)
  s_cbranch_vccz L_s173
  s_waitcnt vmcnt(5)
  s_bitcmp1_b32 vcc_lo, 1
  s_cbranch_scc0 L_s173
  s_waitcnt vmcnt(4)
L_s173:
  buffer_load_dwordx4 v[100:103], v141, s[32:35], s57 offen offset:0 nt
  s_waitcnt vmcnt(8)
  s_cbranch_vccz L_s174
  s_waitcnt vmcnt(5)
  s_bitcmp1_b32 vcc_lo, 1
  s_cbranch_scc0 L_s174
  s_waitcnt vmcnt(4)
L_s174:
  buffer_load_dwordx4 v[104:107], v141, s[32:35], s57 offen offset:128 nt
  s_waitcnt vmcnt(9)
  v_dot2_f32_bf16 v202, v112, v40, 0
  v_dot2_f32_bf16 v202, v113, v41, v202
  v_dot2_f32_bf16 v202, v114, v42, v202
  v_dot2_f32_bf16 v202, v115, v43, v202
  v_dot2_f32_bf16 v202, v116, v44, v202
  v_dot2_f32_bf16 v202, v117, v45, v202
  v_dot2_f32_bf16 v202, v118, v46, v202
  v_dot2_f32_bf16 v202, v119, v47, v202
  v_dot2_f32_bf16 v202, v120, v48, v202
  v_dot2_f32_bf16 v202, v121, v49, v202
  v_dot2_f32_bf16 v202, v122, v50, v202
  v_dot2_f32_bf16 v202, v123, v51, v202
  s_nop 2
  v_add_f32_dpp v202, v202, v202 quad_perm:[1,0,3,2] row_mask:0xf bank_mask:0xf
  s_nop 1
  v_add_f32_dpp v202, v202, v202 quad_perm:[2,3,0,1] row_mask:0xf bank_mask:0xf
  s_nop 1
  v_add_f32_dpp v202, v202, v202 row_half_mirror row_mask:0xf bank_mask:0xf
  v_max_f32 v64, v64, v202
  s_waitcnt vmcnt(7)
  s_cbranch_vccz L_s175
  s_waitcnt vmcnt(5)
  s_bitcmp1_b32 vcc_lo, 1
  s_cbranch_scc0 L_s175
  s_waitcnt vmcnt(4)
L_s175:
  buffer_load_dwordx4 v[108:111], v141, s[32:35], s57 offen offset:256 nt
  s_waitcnt vmcnt(7)
  s_cbranch_vccz L_s176
  s_waitcnt vmcnt(5)
  s_bitcmp1_b32 vcc_lo, 1
  s_cbranch_scc0 L_s176
  s_waitcnt vmcnt(4)
L_s176:
  buffer_load_dwordx4 v[112:115], v142, s[32:35], s57 offen offset:0 nt
  s_waitcnt vmcnt(7)
  s_cbranch_vccz L_s177
  s_waitcnt vmcnt(5)
  s_bitcmp1_b32 vcc_lo, 1
  s_cbranch_scc0 L_s177
  s_waitcnt vmcnt(4)
L_s177:
  buffer_load_dwordx4 v[116:119], v142, s[32:35], s57 offen offset:128 nt
  s_waitcnt vmcnt(8)
  v_dot2_f32_bf16 v203, v124, v40, 0
  v_dot2_f32_bf16 v203, v125, v41, v203
  v_dot2_f32_bf16 v203, v126, v42, v203
  v_dot2_f32_bf16 v203, v127, v43, v203
  v_dot2_f32_bf16 v203, v128, v44, v203
  v_dot2_f32_bf16 v203, v129, v45, v203
  v_dot2_f32_bf16 v203, v130, v46, v203
  v_dot2_f32_bf16 v203, v131, v47, v203
  v_dot2_f32_bf16 v203, v132, v48, v203
  v_dot2_f32_bf16 v203, v133, v49, v203
  v_dot2_f32_bf16 v203, v134, v50, v203
  v_dot2_f32_bf16 v203, v135, v51, v203
  s_nop 2
  v_add_f32_dpp v203, v203, v203 quad_perm:[1,0,3,2] row_mask:0xf bank_mask:0xf
  s_nop 1
  v_add_f32_dpp v203, v203, v203 quad_perm:[2,3,0,1] row_mask:0xf bank_mask:0xf
  s_nop 1
  v_add_f32_dpp v203, v203, v203 row_half_mirror row_mask:0xf bank_mask:0xf
  v_max_f32 v64, v64, v203
  s_branch L_k4
.p2align 7
.type keytab,@object
keytab:
.long 0, 6144, 12288, 18432, 24576, 30720, 102144, 108288, 114432, 120576, 126720, 165888, 172032, 178176, 184320, 190464, 196608, 202752, 208896, 215040, 221184, 227328, 298752, 304896, 311040, 317184, 323328, 362496, 368640, 374784, 380928, 387072
.long 32640, 38784, 44928, 51072, 57216, 63360, 69888, 76032, 82176, 88320, 94464, 133248, 139392, 145536, 151680, 157824, 229248, 235392, 241536, 247680, 253824, 259968, 266496, 272640, 278784, 284928, 291072, 329856, 336000, 342144, 348288, 354432
.long 384, 6528, 12672, 18816, 24960, 31104, 102528, 108672, 114816, 120960, 127104, 166272, 172416, 178560, 184704, 190848, 196992, 203136, 209280, 215424, 221568, 227712, 299136, 305280, 311424, 317568, 323712, 362880, 369024, 375168, 381312, 387456
.long 33024, 39168, 45312, 51456, 57600, 63744, 70272, 76416, 82560, 88704, 94848, 133632, 139776, 145920, 152064, 158208, 229632, 235776, 241920, 248064, 254208, 260352, 266880, 273024, 279168, 285312, 291456, 330240, 336384, 342528, 348672, 354816
.long 768, 6912, 13056, 19200, 25344, 31488, 102912, 109056, 115200, 121344, 127488, 166656, 172800, 178944, 185088, 191232, 197376, 203520, 209664, 215808, 221952, 228096, 299520, 305664, 311808, 317952, 324096, 363264, 369408, 375552, 381696, 387840
.long 33408, 39552, 45696, 51840, 57984, 64128, 70656, 76800, 82944, 89088, 95232, 134016, 140160, 146304, 152448, 158592, 230016, 236160, 242304, 248448, 254592, 260736, 267264, 273408, 279552, 285696, 291840, 330624, 336768, 342912, 349056, 355200
.long 1152, 7296, 13440, 19584, 25728, 31872, 103296, 109440, 115584, 121728, 127872, 167040, 173184, 179328, 185472, 191616, 197760, 203904, 210048, 216192, 222336, 228480, 299904, 306048, 312192, 318336, 324480, 363648, 369792, 375936, 382080, 388224
.long 33792, 39936, 46080, 52224, 58368, 64512, 71040, 77184, 83328, 89472, 95616, 134400, 140544, 146688, 152832, 158976, 230400, 236544, 242688, 248832, 254976, 261120, 267648, 273792, 279936, 286080, 292224, 331008, 337152, 343296, 349440, 355584
.long 1536, 7680, 13824, 19968, 26112, 32256, 103680, 109824, 115968, 122112, 128256, 167424, 173568, 179712, 185856, 192000, 198144, 204288, 210432, 216576, 222720, 228864, 300288, 306432, 312576, 318720, 324864, 364032, 370176, 376320, 382464, 388608
.long 34176, 40320, 46464, 52608, 58752, 64896, 71424, 77568, 83712, 89856, 96000, 134784, 140928, 147072, 153216, 159360, 230784, 236928, 243072, 249216, 255360, 261504, 268032, 274176, 280320, 286464, 292608, 331392, 337536, 343680, 349824, 355968
.long 1920, 8064, 14208, 20352, 26496, 65280, 104064, 110208, 116352, 122496, 128640, 167808, 173952, 180096, 186240, 192384, 198528, 204672, 210816, 216960, 223104, 261888, 300672, 306816, 312960, 319104, 325248, 364416, 370560, 376704, 382848, 388992
.long 34560, 40704, 46848, 52992, 59136, 65664, 71808, 77952, 84096, 90240, 96384, 135168, 141312, 147456, 153600, 159744, 231168, 237312, 243456, 249600, 255744, 262272, 268416, 274560, 280704, 286848, 292992, 331776, 337920, 344064, 350208, 356352
.long 2304, 8448, 14592, 20736, 26880, 98304, 104448, 110592, 116736, 122880, 129024, 168192, 174336, 180480, 186624, 192768, 198912, 205056, 211200, 217344, 223488, 294912, 301056, 307200, 313344, 319488, 325632, 364800, 370944, 377088, 383232, 389376
.long 34944, 41088, 47232, 53376, 59520, 66048, 72192, 78336, 84480, 90624, 96768, 135552, 141696, 147840, 153984, 160128, 231552, 237696, 243840, 249984, 256128, 262656, 268800, 274944, 281088, 287232, 293376, 332160, 338304, 344448, 350592, 356736
.long 2688, 8832, 14976, 21120, 27264, 98688, 104832, 110976, 117120, 123264, 129408, 168576, 174720, 180864, 187008, 193152, 199296, 205440, 211584, 217728, 223872, 295296, 301440, 307584, 313728, 319872, 326016, 365184, 371328, 377472, 383616, 389760
.long 35328, 41472, 47616, 53760, 59904, 66432, 72576, 78720, 84864, 91008, 97152, 135936, 142080, 148224, 154368, 160512, 231936, 238080, 244224, 250368, 256512, 263040, 269184, 275328, 281472, 287616, 293760, 332544, 338688, 344832, 350976, 357120
.long 3072, 9216, 15360, 21504, 27648, 99072, 105216, 111360, 117504, 123648, 129792, 168960, 175104, 181248, 187392, 193536, 199680, 205824, 211968, 218112, 224256, 295680, 301824, 307968, 314112, 320256, 326400, 365568, 371712, 377856, 384000, 390144
.long 35712, 41856, 48000, 54144, 60288, 66816, 72960, 79104, 85248, 91392, 97536, 136320, 142464, 148608, 154752, 160896, 232320, 238464, 244608, 250752, 256896, 263424, 269568, 275712, 281856, 288000, 294144, 332928, 339072, 345216, 351360, 357504
.long 3456, 9600, 15744, 21888, 28032, 99456, 105600, 111744, 117888, 124032, 130176, 169344, 175488, 181632, 187776, 193920, 200064, 206208, 212352, 218496, 224640, 296064, 302208, 308352, 314496, 320640, 326784, 365952, 372096, 378240, 384384, 390528
.long 36096, 42240, 48384, 54528, 60672, 67200, 73344, 79488, 85632, 91776, 97920, 136704, 142848, 148992, 155136, 161280, 232704, 238848, 244992, 251136, 257280, 263808, 269952, 276096, 282240, 288384, 294528, 333312, 339456, 345600, 351744, 357888
.long 3840, 9984, 16128, 22272, 28416, 99840, 105984, 112128, 118272, 124416, 130560, 169728, 175872, 182016, 188160, 194304, 200448, 206592, 212736, 218880, 225024, 296448, 302592, 308736, 314880, 321024, 327168, 366336, 372480, 378624, 384768, 390912
.long 36480, 42624, 48768, 54912, 61056, 67584, 73728, 79872, 86016, 92160, 130944, 137088, 143232, 149376, 155520, 161664, 233088, 239232, 245376, 251520, 257664, 264192, 270336, 276480, 282624, 288768, 327552, 333696, 339840, 345984, 352128, 358272
.long 4224, 10368, 16512, 22656, 28800, 100224, 106368, 112512, 118656, 124800, 163968, 170112, 176256, 182400, 188544, 194688, 200832, 206976, 213120, 219264, 225408, 296832, 302976, 309120, 315264, 321408, 360576, 366720, 372864, 379008, 385152, 391296
.long 36864, 43008, 49152, 55296, 61440, 67968, 74112, 80256, 86400, 92544, 131328, 137472, 143616, 149760, 155904, 162048, 233472, 239616, 245760, 251904, 258048, 264576, 270720, 276864, 283008, 289152, 327936, 334080, 340224, 346368, 352512, 358656
.long 4608, 10752, 16896, 23040, 29184, 100608, 106752, 112896, 119040, 125184, 164352, 170496, 176640, 182784, 188928, 195072, 201216, 207360, 213504, 219648, 225792, 297216, 303360, 309504, 315648, 321792, 360960, 367104, 373248, 379392, 385536, 391680
.long 37248, 43392, 49536, 55680, 61824, 68352, 74496, 80640, 86784, 92928, 131712, 137856, 144000, 150144, 156288, 162432, 233856, 240000, 246144, 252288, 258432, 264960, 271104, 277248, 283392, 289536, 328320, 334464, 340608, 346752, 352896, 359040
.long 4992, 11136, 17280, 23424, 29568, 100992, 107136, 113280, 119424, 125568, 164736, 170880, 177024, 183168, 189312, 195456, 201600, 207744, 213888, 220032, 226176, 297600, 303744, 309888, 316032, 322176, 361344, 367488, 373632, 379776, 385920, 392064
.long 37632, 43776, 49920, 56064, 62208, 68736, 74880, 81024, 87168, 93312, 132096, 138240, 144384, 150528, 156672, 162816, 234240, 240384, 246528, 252672, 258816, 265344, 271488, 277632, 283776, 289920, 328704, 334848, 340992, 347136, 353280, 359424
.long 5376, 11520, 17664, 23808, 29952, 101376, 107520, 113664, 119808, 125952, 165120, 171264, 177408, 183552, 189696, 195840, 201984, 208128, 214272, 220416, 226560, 297984, 304128, 310272, 316416, 322560, 361728, 367872, 374016, 380160, 386304, 392448
.long 38016, 44160, 50304, 56448, 62592, 69120, 75264, 81408, 87552, 93696, 132480, 138624, 144768, 150912, 157056, 163200, 234624, 240768, 246912, 253056, 259200, 265728, 271872, 278016, 284160, 290304, 329088, 335232, 341376, 347520, 353664, 359808
.long 5760, 11904, 18048, 24192, 30336, 101760, 107904, 114048, 120192, 126336, 165504, 171648, 177792, 183936, 190080, 196224, 202368, 208512, 214656, 220800, 226944, 298368, 304512, 310656, 316800, 322944, 362112, 368256, 374400, 380544, 386688, 392832
.long 38400, 44544, 50688, 56832, 62976, 69504, 75648, 81792, 87936, 94080, 132864, 139008, 145152, 151296, 157440, 163584, 235008, 241152, 247296, 253440, 259584, 266112, 272256, 278400, 284544, 290688, 329472, 335616, 341760, 347904, 354048, 360192
.size keytab, 4096
.section .rodata,"a"
.p2align 6
.amdhsa_kernel concat_heads__gqa_block_cached__mha_block_cached__decode_kernel
  .amdhsa_next_free_vgpr 252
  .amdhsa_next_free_sgpr 84
  .amdhsa_accum_offset 252
  .amdhsa_group_segment_fixed_size 0
  .amdhsa_kernarg_size 104
  .amdhsa_user_sgpr_count 2
  .amdhsa_user_sgpr_kernarg_segment_ptr 1
  .amdhsa_system_sgpr_workgroup_id_x 1
  .amdhsa_float_denorm_mode_32 3
.end_amdhsa_kernel
```
